```python
import torch

def _softmax(x, axis=-1):
    return torch.softmax(x, dim=axis)
def _gelu(x):
    return torch.nn.functional.gelu(x, approximate="tanh")
def _silu(x):
    return torch.nn.functional.silu(x)
def _sigmoid(x):
    return torch.sigmoid(x)
def _layernorm(x, axis=-1, eps=1e-5):
    m = x.mean(dim=axis, keepdim=True)
    v = x.var(dim=axis, keepdim=True, unbiased=False)
    return (x - m) / torch.sqrt(v + eps)
def _scatter_add(tgt, idx, src, axis=0):
    return tgt.clone().index_add_(axis, idx, src)
def _segment_sum(src, seg, n):
    out = torch.zeros((n,) + src.shape[1:], dtype=src.dtype)
    return out.index_add_(0, seg, src)
def _pad(x, pw):
    flat = tuple(v for pair in reversed(pw) for v in pair)
    return torch.nn.functional.pad(x, flat)

kernel_name = 'concat_heads__softmax_full_mha__ssm_conv_s4d__prompt'

def setup_inputs():

    _w = (lambda a: (lambda t: t.to(torch.bfloat16) if t.is_floating_point() else t)(torch.as_tensor(a)))
    def _A_setup():
        B, S, D = 1, 2048, 512
        return {
            "x": _w((lambda *s: torch.randn(*s, dtype=torch.bfloat16) * 0.2)(B, S, D)),
            "wqkv": _w((lambda *s: torch.randn(*s, dtype=torch.bfloat16) * 0.2)(D, 3 * D)),
            "wo": _w((lambda *s: torch.randn(*s, dtype=torch.bfloat16) * 0.05)(D, D)),
        }
    _A_in = _A_setup()

    def _B_setup():
        Bsz, L, D, N = 1, 2048, 512, 128
        return {
            "u": _w((lambda *s: torch.randn(*s, dtype=torch.bfloat16) * 0.05)(Bsz, L, D)),
            "log_A_real": _w((lambda *s: torch.randn(*s, dtype=torch.bfloat16) * 6.4)(D, N) * 0.5),
            "A_imag": _w((lambda *s: torch.randn(*s, dtype=torch.bfloat16) * 0.05)(D, N) * 3.14),
            "C_real": _w((lambda *s: torch.randn(*s, dtype=torch.bfloat16) * 0.4)(D, N) / N ** 0.5),
            "C_imag": _w((lambda *s: torch.randn(*s, dtype=torch.bfloat16) * 0.4)(D, N) / N ** 0.5),
            "log_dt": _w((lambda *s: torch.randn(*s, dtype=torch.bfloat16) * 0.05)(D) * 0.5 - 4.0),
            "D_skip": _w((lambda *s: torch.randn(*s, dtype=torch.bfloat16) * 0.05)(D)),
        }
    _B_in = _B_setup()

    return {
        "A_x": _A_in["x"],
        "A_wqkv": _A_in["wqkv"],
        "A_wo": _A_in["wo"],
        "B_u": _B_in["u"],
        "B_log_A_real": _B_in["log_A_real"],
        "B_A_imag": _B_in["A_imag"],
        "B_C_real": _B_in["C_real"],
        "B_C_imag": _B_in["C_imag"],
        "B_log_dt": _B_in["log_dt"],
        "B_D_skip": _B_in["D_skip"],
    }

def reference(A_x, A_wqkv, A_wo, B_u, B_log_A_real, B_A_imag, B_C_real, B_C_imag, B_log_dt, B_D_skip):
    def _A_ref(x, wqkv, wo):
        B, S, D = x.shape
        H = 32; Dh = D // H
        qkv = (lambda x, *d: x.permute(*d))((x @ wqkv).reshape(B, S, 3, H, Dh), 2, 0, 3, 1, 4)
        q, k, v = qkv[0], qkv[1], qkv[2]
        scale = Dh ** -0.5
        scores = torch.einsum("bhqd,bhkd->bhqk", q, k) * scale
        p = _softmax(scores, axis=-1)
        o = torch.einsum("bhqk,bhkd->bhqd", p, v)
        return (lambda x, *d: x.permute(*d))(o, 0, 2, 1, 3).reshape(B, S, D) @ wo

    def _B_ref(u, log_A_real, A_imag, C_real, C_imag, log_dt, D_skip):
        L = u.shape[1]
        dt = torch.exp(log_dt)
        A = -torch.exp(log_A_real) + 1j * A_imag
        C = (C_real + 1j * C_imag) * dt[:, None]
        pos = (lambda x, dt: x.to(dt))(torch.arange(L), log_dt.dtype)
        P = torch.exp((A * dt[:, None])[:, :, None] * pos[None, None, :])
        K = 2.0 * torch.einsum("dn,dnl->dl", C, P).real
        L2 = 2 * L
        u_t = (lambda x, *d: x.permute(*d))(u, 0, 2, 1)
        Kf = (lambda x, *a, **k: torch.fft.rfft(x.float(), *a, **k))(K, L2)
        Uf = (lambda x, *a, **k: torch.fft.rfft(x.float(), *a, **k))(u_t, L2)
        y = (lambda x, *a, **k: torch.fft.irfft(x, *a, **k).to(torch.bfloat16))(Uf * Kf[None, :, :], L2)[:, :, :L]
        y = (lambda x, *d: x.permute(*d))(y, 0, 2, 1)
        return y + u * D_skip[None, None, :]

    a = _A_ref(A_x, A_wqkv, A_wo)
    b = _B_ref(B_u, B_log_A_real, B_A_imag, B_C_real, B_C_imag, B_log_dt, B_D_skip)
    return torch.concatenate([a, b], axis=-1)
```

```asm
; @launch grid=(256,1,1) block=(512,1,1) lds=163840
.amdgcn_target "amdgcn-amd-amdhsa--gfx950"
.text
.globl concat_heads__softmax_full_mha__ssm_conv_s4d__prompt_kernel
.p2align 8
.type concat_heads__softmax_full_mha__ssm_conv_s4d__prompt_kernel,@function
concat_heads__softmax_full_mha__ssm_conv_s4d__prompt_kernel:
    s_cmp_ge_u32 s2, 256
    s_cbranch_scc1 concat_heads__softmax_full_mha__ssm_conv_s4d__prompt_kernel_end
    s_load_dwordx8 s[36:43], s[0:1], 0
    s_load_dwordx2 s[68:69], s[0:1], 96
    s_load_dwordx4 s[44:47], s[0:1], 32
    s_load_dwordx2 s[48:49], s[0:1], 48
    s_load_dwordx8 s[60:67], s[0:1], 56
    s_and_b32 s8, s2, 7
    s_lshr_b32 s9, s2, 3
    s_and_b32 s4, s8, 1
    s_lshl_b32 s4, s4, 2
    s_and_b32 s10, s9, 3
    s_add_u32 s4, s4, s10
    s_lshr_b32 s3, s8, 1
    s_lshl_b32 s3, s3, 3
    s_lshr_b32 s10, s9, 2
    s_add_u32 s3, s3, s10
    s_add_u32 s35, s9, s2
    s_and_b32 s35, s35, 7
    v_lshrrev_b32 v2, 6, v0
    v_and_b32 v1, 63, v0
    v_readfirstlane_b32 s5, v2
    v_lshrrev_b32 v2, 3, v1
    s_lshl_b32 s8, s5, 3
    v_add_u32 v25, s8, v2
    v_bfe_u32 v3, v25, 1, 3
    v_and_b32 v4, 7, v1
    v_xor_b32 v3, v3, v4
    s_lshl_b32 s9, s3, 6
    v_add_u32 v5, s9, v25
    v_lshlrev_b32 v9, 10, v5
    v_lshl_add_u32 v6, v3, 4, v9
    s_lshl_b32 s10, s4, 7
    v_lshrrev_b32 v2, 4, v1
    v_add_u32 v3, s8, v2
    v_mul_u32_u24 v7, 3072, v3
    v_bfe_u32 v3, v1, 2, 2
    v_xor_b32 v3, v3, v2
    v_and_b32 v4, 1, v3
    v_lshl_add_u32 v7, v4, 6, v7
    v_lshrrev_b32 v4, 1, v3
    v_lshl_add_u32 v7, v4, 10, v7
    v_and_b32 v4, 3, v1
    v_lshl_add_u32 v7, v4, 4, v7
    s_add_u32 s11, s10, 1024
    v_add_u32 v7, s11, v7
    s_lshl_b32 s28, s5, 10
    s_lshl_b32 s29, s5, 11
    s_add_u32 s29, s29, 8192
    s_waitcnt lgkmcnt(0)
    s_mov_b32 s12, s36
    s_and_b32 s13, s37, 0xffff
    s_mov_b32 s14, 0x200000
    s_mov_b32 s15, 0x20000
    s_mov_b32 s16, s38
    s_and_b32 s17, s39, 0xffff
    s_mov_b32 s18, 0x180000
    s_mov_b32 s19, 0x20000
    s_add_u32 s8, s35, 0
    s_and_b32 s8, s8, 7
    s_mul_i32 s9, s8, 196608
    s_lshl_b32 s8, s8, 7
    s_add_u32 m0, s28, 0
    s_add_u32 s10, s9, 12288
    buffer_load_dwordx4 v6, s[12:15], s8 offen lds
    s_add_u32 m0, s29, 0
    s_nop 0
    buffer_load_dwordx4 v7, s[16:19], s9 offen lds
    s_add_u32 m0, s29, 1024
    s_nop 0
    buffer_load_dwordx4 v7, s[16:19], s10 offen lds
    s_mov_b32 s20, s42
    s_and_b32 s21, s43, 0xffff
    s_mov_b32 s22, 0x200000
    s_mov_b32 s23, 0x20000
    s_mov_b32 s24, s68
    s_and_b32 s25, s69, 0xffff
    s_mov_b32 s26, 0x10000000
    s_mov_b32 s27, 0x20000
    s_barrier
    s_add_u32 s8, s35, 1
    s_and_b32 s8, s8, 7
    s_mul_i32 s9, s8, 196608
    s_lshl_b32 s8, s8, 7
    s_add_u32 m0, s28, 24576
    s_add_u32 s10, s9, 12288
    buffer_load_dwordx4 v6, s[12:15], s8 offen lds
    s_add_u32 m0, s29, 24576
    s_nop 0
    buffer_load_dwordx4 v7, s[16:19], s9 offen lds
    s_add_u32 m0, s29, 25600
    s_nop 0
    buffer_load_dwordx4 v7, s[16:19], s10 offen lds
    s_barrier
    s_add_u32 s8, s35, 2
    s_and_b32 s8, s8, 7
    s_mul_i32 s9, s8, 196608
    s_lshl_b32 s8, s8, 7
    s_add_u32 m0, s28, 49152
    s_add_u32 s10, s9, 12288
    buffer_load_dwordx4 v6, s[12:15], s8 offen lds
    s_add_u32 m0, s29, 49152
    s_nop 0
    buffer_load_dwordx4 v7, s[16:19], s9 offen lds
    s_add_u32 m0, s29, 50176
    s_nop 0
    buffer_load_dwordx4 v7, s[16:19], s10 offen lds
    v_and_b32 v4, 7, v1
    s_add_u32 s11, s4, s3
    s_and_b32 s11, s11, 7
    s_lshl_b32 s11, s11, 7
    v_lshl_add_u32 v9, v4, 4, v9
    v_add_u32 v9, s11, v9
    s_lshl_b32 s10, s4, 7
    v_mul_u32_u24 v8, 3072, v25
    v_lshrrev_b32 v3, 2, v4
    v_bfe_u32 v5, v1, 4, 1
    v_xor_b32 v3, v3, v5
    v_lshl_add_u32 v8, v3, 6, v8
    v_and_b32 v3, 3, v4
    v_lshl_add_u32 v8, v3, 4, v8
    v_add_u32 v8, s10, v8
    s_lshr_b32 s50, s5, 2
    s_bfe_u32 s51, s5, 0x10001
    s_and_b32 s52, s5, 1
    s_lshl_b32 s53, s4, 5
    s_add_u32 s53, s53, s3
    v_and_b32 v2, 31, v1
    v_lshrrev_b32 v3, 5, v1
    v_bfe_u32 v4, v1, 1, 3
    v_xor_b32 v3, v3, v4
    s_lshl_b32 s8, s51, 5
    v_add_u32 v2, s8, v2
    v_lshlrev_b32 v2, 7, v2
    v_xor_b32 v4, 0, v3
    v_lshl_add_u32 v14, v4, 4, v2
    v_add_u32 v18, 49152, v14
    v_xor_b32 v4, 2, v3
    v_lshl_add_u32 v15, v4, 4, v2
    v_add_u32 v19, 49152, v15
    v_xor_b32 v4, 4, v3
    v_lshl_add_u32 v16, v4, 4, v2
    v_add_u32 v20, 49152, v16
    v_xor_b32 v4, 6, v3
    v_lshl_add_u32 v17, v4, 4, v2
    v_add_u32 v21, 49152, v17
    v_bfe_u32 v2, v1, 2, 2
    v_lshrrev_b32 v3, 5, v1
    v_lshl_add_u32 v3, v3, 3, v2
    v_bfe_u32 v4, v1, 4, 1
    v_lshlrev_b32 v4, 5, v4
    v_and_b32 v5, 3, v1
    v_lshl_add_u32 v4, v5, 3, v4
    s_lshl_b32 s8, s50, 1
    s_add_u32 s8, s8, s52
    v_xor_b32 v5, s8, v2
    v_lshl_add_u32 v22, v5, 6, v4
    v_lshl_add_u32 v22, v3, 8, v22
    v_add_u32 v22, 8192, v22
    v_add_u32 v23, 49152, v22
    v_lshrrev_b32 v5, 1, v2
    v_xor_b32 v5, s52, v5
    v_lshl_add_u32 v24, v5, 6, v4
    v_lshl_add_u32 v24, v3, 7, v24
    s_mul_i32 s8, s50, 49152
    v_add_u32 v24, s8, v24
    v_mov_b32 v32, 0
    v_mov_b32 v33, 0
    v_mov_b32 v34, 0
    v_mov_b32 v35, 0
    v_mov_b32 v36, 0
    v_mov_b32 v37, 0
    v_mov_b32 v38, 0
    v_mov_b32 v39, 0
    v_mov_b32 v40, 0
    v_mov_b32 v41, 0
    v_mov_b32 v42, 0
    v_mov_b32 v43, 0
    v_mov_b32 v44, 0
    v_mov_b32 v45, 0
    v_mov_b32 v46, 0
    v_mov_b32 v47, 0
    v_mov_b32 v2, 163600
    v_mov_b32 v4, 0
    v_mov_b32 v5, 0
    ds_write_b64 v2, v[4:5]
    ds_write_b64 v2, v[4:5] offset:8
    ds_write_b64 v2, v[4:5] offset:16
    s_cmp_eq_u32 s50, 1
    s_cbranch_scc1 concat_heads__softmax_full_mha__ssm_conv_s4d__prompt_kernel_v
    s_waitcnt vmcnt(6) lgkmcnt(0)
    s_barrier
    s_add_u32 s8, s35, 3
    s_and_b32 s8, s8, 7
    s_mul_i32 s9, s8, 196608
    s_lshl_b32 s8, s8, 7
    s_add_u32 m0, s28, 73728
    s_add_u32 s10, s9, 12288
    buffer_load_dwordx4 v6, s[12:15], s8 offen lds
    ds_read_b128 v[128:131], v14 offset:0
    ds_read_b64_tr_b16 v[96:97], v22 offset:0
    ds_read_b64_tr_b16 v[98:99], v22 offset:1024
    s_add_u32 m0, s29, 73728
    s_nop 0
    buffer_load_dwordx4 v7, s[16:19], s9 offen lds
    ds_read_b128 v[132:135], v15 offset:0
    ds_read_b64_tr_b16 v[100:101], v22 offset:4096
    ds_read_b64_tr_b16 v[102:103], v22 offset:5120
    s_add_u32 m0, s29, 74752
    s_nop 0
    buffer_load_dwordx4 v7, s[16:19], s10 offen lds
    ds_read_b128 v[136:139], v16 offset:0
    ds_read_b64_tr_b16 v[104:105], v22 offset:8192
    ds_read_b64_tr_b16 v[106:107], v22 offset:9216
    ds_read_b128 v[140:143], v17 offset:0
    ds_read_b64_tr_b16 v[108:109], v22 offset:12288
    ds_read_b64_tr_b16 v[110:111], v22 offset:13312
    s_waitcnt vmcnt(6) lgkmcnt(0)
    s_barrier
    s_add_u32 s8, s35, 4
    s_and_b32 s8, s8, 7
    s_mul_i32 s9, s8, 196608
    s_lshl_b32 s8, s8, 7
    s_add_u32 m0, s28, 0
    s_add_u32 s10, s9, 12288
    buffer_load_dwordx4 v6, s[12:15], s8 offen lds
    ds_read_b128 v[144:147], v14 offset:24576
    ds_read_b64_tr_b16 v[80:81], v22 offset:24576
    ds_read_b64_tr_b16 v[82:83], v22 offset:25600
    v_mfma_f32_32x32x16_bf16 v[32:47], v[96:99], v[128:131], v[32:47]
    s_add_u32 m0, s29, 0
    s_nop 0
    buffer_load_dwordx4 v7, s[16:19], s9 offen lds
    ds_read_b128 v[148:151], v15 offset:24576
    ds_read_b64_tr_b16 v[84:85], v22 offset:28672
    ds_read_b64_tr_b16 v[86:87], v22 offset:29696
    v_mfma_f32_32x32x16_bf16 v[32:47], v[100:103], v[132:135], v[32:47]
    s_add_u32 m0, s29, 1024
    s_nop 0
    buffer_load_dwordx4 v7, s[16:19], s10 offen lds
    ds_read_b128 v[152:155], v16 offset:24576
    ds_read_b64_tr_b16 v[88:89], v22 offset:32768
    ds_read_b64_tr_b16 v[90:91], v22 offset:33792
    v_mfma_f32_32x32x16_bf16 v[32:47], v[104:107], v[136:139], v[32:47]
    ds_read_b128 v[156:159], v17 offset:24576
    ds_read_b64_tr_b16 v[92:93], v22 offset:36864
    ds_read_b64_tr_b16 v[94:95], v22 offset:37888
    v_mfma_f32_32x32x16_bf16 v[32:47], v[108:111], v[140:143], v[32:47]
    s_waitcnt vmcnt(6) lgkmcnt(0)
    s_barrier
    s_add_u32 s8, s35, 5
    s_and_b32 s8, s8, 7
    s_mul_i32 s9, s8, 196608
    s_lshl_b32 s8, s8, 7
    s_add_u32 m0, s28, 24576
    s_add_u32 s10, s9, 12288
    buffer_load_dwordx4 v6, s[12:15], s8 offen lds
    ds_read_b128 v[160:163], v18 offset:0
    ds_read_b64_tr_b16 v[96:97], v23 offset:0
    ds_read_b64_tr_b16 v[98:99], v23 offset:1024
    v_mfma_f32_32x32x16_bf16 v[32:47], v[80:83], v[144:147], v[32:47]
    s_add_u32 m0, s29, 24576
    s_nop 0
    buffer_load_dwordx4 v7, s[16:19], s9 offen lds
    ds_read_b128 v[164:167], v19 offset:0
    ds_read_b64_tr_b16 v[100:101], v23 offset:4096
    ds_read_b64_tr_b16 v[102:103], v23 offset:5120
    v_mfma_f32_32x32x16_bf16 v[32:47], v[84:87], v[148:151], v[32:47]
    s_add_u32 m0, s29, 25600
    s_nop 0
    buffer_load_dwordx4 v7, s[16:19], s10 offen lds
    ds_read_b128 v[168:171], v20 offset:0
    ds_read_b64_tr_b16 v[104:105], v23 offset:8192
    ds_read_b64_tr_b16 v[106:107], v23 offset:9216
    v_mfma_f32_32x32x16_bf16 v[32:47], v[88:91], v[152:155], v[32:47]
    ds_read_b128 v[172:175], v21 offset:0
    ds_read_b64_tr_b16 v[108:109], v23 offset:12288
    ds_read_b64_tr_b16 v[110:111], v23 offset:13312
    v_mfma_f32_32x32x16_bf16 v[32:47], v[92:95], v[156:159], v[32:47]
    s_waitcnt vmcnt(6) lgkmcnt(0)
    s_barrier
    s_add_u32 s8, s35, 6
    s_and_b32 s8, s8, 7
    s_mul_i32 s9, s8, 196608
    s_lshl_b32 s8, s8, 7
    s_add_u32 m0, s28, 49152
    s_add_u32 s10, s9, 12288
    buffer_load_dwordx4 v6, s[12:15], s8 offen lds
    ds_read_b128 v[176:179], v18 offset:24576
    ds_read_b64_tr_b16 v[80:81], v23 offset:24576
    ds_read_b64_tr_b16 v[82:83], v23 offset:25600
    v_mfma_f32_32x32x16_bf16 v[32:47], v[96:99], v[160:163], v[32:47]
    s_add_u32 m0, s29, 49152
    s_nop 0
    buffer_load_dwordx4 v7, s[16:19], s9 offen lds
    ds_read_b128 v[180:183], v19 offset:24576
    ds_read_b64_tr_b16 v[84:85], v23 offset:28672
    ds_read_b64_tr_b16 v[86:87], v23 offset:29696
    v_mfma_f32_32x32x16_bf16 v[32:47], v[100:103], v[164:167], v[32:47]
    s_add_u32 m0, s29, 50176
    s_nop 0
    buffer_load_dwordx4 v7, s[16:19], s10 offen lds
    ds_read_b128 v[184:187], v20 offset:24576
    ds_read_b64_tr_b16 v[88:89], v23 offset:32768
    ds_read_b64_tr_b16 v[90:91], v23 offset:33792
    v_mfma_f32_32x32x16_bf16 v[32:47], v[104:107], v[168:171], v[32:47]
    ds_read_b128 v[188:191], v21 offset:24576
    ds_read_b64_tr_b16 v[92:93], v23 offset:36864
    ds_read_b64_tr_b16 v[94:95], v23 offset:37888
    v_mfma_f32_32x32x16_bf16 v[32:47], v[108:111], v[172:175], v[32:47]
    s_waitcnt vmcnt(6) lgkmcnt(0)
    s_barrier
    s_add_u32 s8, s35, 7
    s_and_b32 s8, s8, 7
    s_mul_i32 s9, s8, 196608
    s_lshl_b32 s8, s8, 7
    s_add_u32 m0, s28, 73728
    s_add_u32 s10, s9, 12288
    buffer_load_dwordx4 v6, s[12:15], s8 offen lds
    ds_read_b128 v[64:67], v14 offset:0
    ds_read_b64_tr_b16 v[96:97], v22 offset:0
    ds_read_b64_tr_b16 v[98:99], v22 offset:1024
    v_mfma_f32_32x32x16_bf16 v[32:47], v[80:83], v[176:179], v[32:47]
    s_add_u32 m0, s29, 73728
    s_nop 0
    buffer_load_dwordx4 v7, s[16:19], s9 offen lds
    ds_read_b128 v[68:71], v15 offset:0
    ds_read_b64_tr_b16 v[100:101], v22 offset:4096
    ds_read_b64_tr_b16 v[102:103], v22 offset:5120
    v_mfma_f32_32x32x16_bf16 v[32:47], v[84:87], v[180:183], v[32:47]
    s_add_u32 m0, s29, 74752
    s_nop 0
    buffer_load_dwordx4 v7, s[16:19], s10 offen lds
    ds_read_b128 v[72:75], v16 offset:0
    ds_read_b64_tr_b16 v[104:105], v22 offset:8192
    ds_read_b64_tr_b16 v[106:107], v22 offset:9216
    v_mfma_f32_32x32x16_bf16 v[32:47], v[88:91], v[184:187], v[32:47]
    ds_read_b128 v[76:79], v17 offset:0
    ds_read_b64_tr_b16 v[108:109], v22 offset:12288
    ds_read_b64_tr_b16 v[110:111], v22 offset:13312
    v_mfma_f32_32x32x16_bf16 v[32:47], v[92:95], v[188:191], v[32:47]
    s_waitcnt vmcnt(6) lgkmcnt(0)
    s_barrier
    s_add_u32 s8, s35, 0
    s_and_b32 s8, s8, 7
    s_mul_i32 s9, s8, 196608
    s_add_u32 m0, s28, 0
    s_nop 0
    buffer_load_dwordx4 v8, s[16:19], s9 offen lds
    ds_read_b128 v[112:115], v14 offset:24576
    ds_read_b64_tr_b16 v[80:81], v22 offset:24576
    ds_read_b64_tr_b16 v[82:83], v22 offset:25600
    v_mfma_f32_32x32x16_bf16 v[32:47], v[96:99], v[64:67], v[32:47]
    s_add_u32 s8, s35, 1
    s_and_b32 s8, s8, 7
    s_mul_i32 s9, s8, 196608
    s_add_u32 m0, s28, 8192
    s_nop 0
    buffer_load_dwordx4 v8, s[16:19], s9 offen lds
    ds_read_b128 v[116:119], v15 offset:24576
    ds_read_b64_tr_b16 v[84:85], v22 offset:28672
    ds_read_b64_tr_b16 v[86:87], v22 offset:29696
    v_mfma_f32_32x32x16_bf16 v[32:47], v[100:103], v[68:71], v[32:47]
    ds_read_b128 v[120:123], v16 offset:24576
    ds_read_b64_tr_b16 v[88:89], v22 offset:32768
    ds_read_b64_tr_b16 v[90:91], v22 offset:33792
    v_mfma_f32_32x32x16_bf16 v[32:47], v[104:107], v[72:75], v[32:47]
    ds_read_b128 v[124:127], v17 offset:24576
    ds_read_b64_tr_b16 v[92:93], v22 offset:36864
    ds_read_b64_tr_b16 v[94:95], v22 offset:37888
    v_mfma_f32_32x32x16_bf16 v[32:47], v[108:111], v[76:79], v[32:47]
    v_mov_b32 v30, 14745600
    buffer_load_dwordx2 v[28:29], v30, s[24:27], 0 offen sc1
    s_lshl_b32 s50, s4, 6
    s_lshl_b32 s51, s3, 1
    s_add_u32 s50, s50, s51
    s_and_b32 s51, s5, 1
    s_add_u32 s51, s50, s51
    s_lshl_b32 s52, s51, 8
    s_bfe_u32 s53, s5, 0x10001
    s_lshl_b32 s53, s53, 7
    s_add_u32 s52, s52, s53
    s_lshl_b32 s53, s51, 1
    v_lshl_add_u32 v210, v1, 1, s52
    v_mov_b32 v211, s53
    global_load_ushort v204, v210, s[44:45]
    global_load_ushort v205, v210, s[46:47]
    global_load_ushort v206, v210, s[48:49]
    global_load_ushort v207, v210, s[60:61]
    global_load_ushort v208, v211, s[62:63]
    global_load_ushort v209, v211, s[64:65]
    s_lshr_b32 s50, s5, 2
    s_bfe_u32 s51, s5, 0x10001
    s_and_b32 s52, s5, 1
    s_lshl_b32 s53, s4, 5
    s_add_u32 s53, s53, s3
    s_waitcnt vmcnt(12) lgkmcnt(0)
    s_barrier
    s_add_u32 s8, s35, 2
    s_and_b32 s8, s8, 7
    s_mul_i32 s9, s8, 196608
    s_add_u32 m0, s28, 24576
    s_nop 0
    buffer_load_dwordx4 v8, s[16:19], s9 offen lds
    ds_read_b128 v[64:67], v18 offset:0
    ds_read_b64_tr_b16 v[96:97], v23 offset:0
    ds_read_b64_tr_b16 v[98:99], v23 offset:1024
    v_mfma_f32_32x32x16_bf16 v[32:47], v[80:83], v[112:115], v[32:47]
    s_add_u32 s8, s35, 3
    s_and_b32 s8, s8, 7
    s_mul_i32 s9, s8, 196608
    s_add_u32 m0, s28, 32768
    s_nop 0
    buffer_load_dwordx4 v8, s[16:19], s9 offen lds
    ds_read_b128 v[68:71], v19 offset:0
    ds_read_b64_tr_b16 v[100:101], v23 offset:4096
    ds_read_b64_tr_b16 v[102:103], v23 offset:5120
    v_mfma_f32_32x32x16_bf16 v[32:47], v[84:87], v[116:119], v[32:47]
    ds_read_b128 v[72:75], v20 offset:0
    ds_read_b64_tr_b16 v[104:105], v23 offset:8192
    ds_read_b64_tr_b16 v[106:107], v23 offset:9216
    v_mfma_f32_32x32x16_bf16 v[32:47], v[88:91], v[120:123], v[32:47]
    ds_read_b128 v[76:79], v21 offset:0
    ds_read_b64_tr_b16 v[108:109], v23 offset:12288
    ds_read_b64_tr_b16 v[110:111], v23 offset:13312
    v_mfma_f32_32x32x16_bf16 v[32:47], v[92:95], v[124:127], v[32:47]
    s_waitcnt vmcnt(11) lgkmcnt(0)
    s_barrier
    s_add_u32 s8, s35, 4
    s_and_b32 s8, s8, 7
    s_mul_i32 s9, s8, 196608
    s_add_u32 m0, s28, 49152
    s_nop 0
    buffer_load_dwordx4 v8, s[16:19], s9 offen lds
    ds_read_b128 v[112:115], v18 offset:24576
    ds_read_b64_tr_b16 v[80:81], v23 offset:24576
    ds_read_b64_tr_b16 v[82:83], v23 offset:25600
    v_mfma_f32_32x32x16_bf16 v[32:47], v[96:99], v[64:67], v[32:47]
    s_add_u32 s8, s35, 5
    s_and_b32 s8, s8, 7
    s_mul_i32 s9, s8, 196608
    s_add_u32 m0, s28, 57344
    s_nop 0
    buffer_load_dwordx4 v8, s[16:19], s9 offen lds
    ds_read_b128 v[116:119], v19 offset:24576
    ds_read_b64_tr_b16 v[84:85], v23 offset:28672
    ds_read_b64_tr_b16 v[86:87], v23 offset:29696
    v_mfma_f32_32x32x16_bf16 v[32:47], v[100:103], v[68:71], v[32:47]
    ds_read_b128 v[120:123], v20 offset:24576
    ds_read_b64_tr_b16 v[88:89], v23 offset:32768
    ds_read_b64_tr_b16 v[90:91], v23 offset:33792
    v_mfma_f32_32x32x16_bf16 v[32:47], v[104:107], v[72:75], v[32:47]
    ds_read_b128 v[124:127], v21 offset:24576
    ds_read_b64_tr_b16 v[92:93], v23 offset:36864
    ds_read_b64_tr_b16 v[94:95], v23 offset:37888
    v_mfma_f32_32x32x16_bf16 v[32:47], v[108:111], v[76:79], v[32:47]
    s_waitcnt lgkmcnt(0)
    v_mfma_f32_32x32x16_bf16 v[32:47], v[80:83], v[112:115], v[32:47]
    v_mfma_f32_32x32x16_bf16 v[32:47], v[84:87], v[116:119], v[32:47]
    v_mfma_f32_32x32x16_bf16 v[32:47], v[88:91], v[120:123], v[32:47]
    v_mfma_f32_32x32x16_bf16 v[32:47], v[92:95], v[124:127], v[32:47]
    s_lshl_b32 s8, s4, 2
    s_lshl_b32 s9, s52, 1
    s_add_u32 s8, s8, s9
    s_lshl_b32 s8, s8, 1
    s_add_u32 s8, s8, s51
    s_lshl_b32 s10, s8, 16
    s_lshl_b32 s9, s3, 11
    s_add_u32 s10, s10, s9
    s_nop 3
    v_cvt_pk_bf16_f32 v64, v32, v33
    v_cvt_pk_bf16_f32 v65, v34, v35
    v_cvt_pk_bf16_f32 v66, v36, v37
    v_cvt_pk_bf16_f32 v67, v38, v39
    v_cvt_pk_bf16_f32 v68, v40, v41
    v_cvt_pk_bf16_f32 v69, v42, v43
    v_cvt_pk_bf16_f32 v70, v44, v45
    v_cvt_pk_bf16_f32 v71, v46, v47
    v_lshlrev_b32 v2, 4, v1
    buffer_store_dwordx4 v[64:67], v2, s[24:27], s10 offen sc1
    s_add_u32 s8, s10, 131072
    buffer_store_dwordx4 v[68:71], v2, s[24:27], s8 offen sc1
    v_mov_b32 v76, 0
    v_mov_b32 v77, 0
    v_dot2_f32_bf16 v76, v64, v64, v76
    v_dot2_f32_bf16 v77, v68, v68, v77
    v_dot2_f32_bf16 v76, v65, v65, v76
    v_dot2_f32_bf16 v77, v69, v69, v77
    v_dot2_f32_bf16 v76, v66, v66, v76
    v_dot2_f32_bf16 v77, v70, v70, v77
    v_dot2_f32_bf16 v76, v67, v67, v76
    v_dot2_f32_bf16 v77, v71, v71, v77
    s_nop 1
    v_mov_b32 v78, v76
    v_mov_b32 v79, v77
    s_nop 0
    v_permlane32_swap_b32 v76, v78
    v_permlane32_swap_b32 v77, v79
    v_add_f32 v76, v76, v78
    v_add_f32 v77, v77, v79
    v_max_f32 v76, v76, v77
    v_mov_b32 v77, 0x43640000
    v_cmp_nle_f32 vcc, v76, v77
    s_nop 0
    s_cmp_eq_u64 vcc, 0
    s_cbranch_scc1 concat_heads__softmax_full_mha__ssm_conv_s4d__prompt_kernel_nb_k
    v_mov_b32 v2, 163600
    v_mov_b32 v3, 1
    ds_write_b32 v2, v3
concat_heads__softmax_full_mha__ssm_conv_s4d__prompt_kernel_nb_k:
    s_waitcnt vmcnt(6)
    v_readfirstlane_b32 s98, v28
    v_readfirstlane_b32 s99, v29
    s_mul_i32 s98, s98, 0x9E3779B1
    s_add_u32 s98, s98, 0x7F4A7C15
    s_mul_i32 s99, s99, 0x85EBCA6D
    s_add_u32 s99, s99, 0x165667B1
    s_and_b32 s99, s99, 0xfffffffe
    s_waitcnt lgkmcnt(0)
    s_barrier
    s_lshl_b32 s49, s4, 5
    s_cmp_lg_u32 s5, 0
    s_cbranch_scc1 concat_heads__softmax_full_mha__ssm_conv_s4d__prompt_kernel_rb
    v_mov_b32 v2, 163600
    ds_read_b32 v3, v2
    s_waitcnt lgkmcnt(0)
    v_readfirstlane_b32 s31, v3
    s_nop 0
    s_xor_b32 s31, s31, s99
concat_heads__softmax_full_mha__ssm_conv_s4d__prompt_kernel_rb:
    buffer_load_dwordx4 v[10:13], v9, s[20:23], 0 offen
    v_lshlrev_b32 v204, 16, v204
    v_lshlrev_b32 v205, 16, v205
    v_lshlrev_b32 v206, 16, v206
    v_lshlrev_b32 v207, 16, v207
    v_lshlrev_b32 v208, 16, v208
    v_mul_f32 v208, 0x3fb8aa3b, v208
    v_mul_f32 v204, 0x3fb8aa3b, v204
    v_exp_f32 v208, v208
    v_exp_f32 v204, v204
    s_and_b32 s54, s5, 1
    s_mul_i32 s54, s54, 16896
    v_cvt_pk_bf16_f32 v208, v208, v208
    v_cvt_pk_bf16_f32 v204, v204, v204
    s_bfe_u32 s55, s5, 0x10001
    s_lshl_b32 s55, s55, 8
    v_lshrrev_b32 v2, 4, v1
    s_lshl_b32 s8, s3, 4
    s_lshl_b32 s9, s5, 2
    s_add_u32 s8, s8, s9
    v_add_u32 v3, s8, v2
    v_lshlrev_b32 v200, 10, v3
    v_bfe_u32 v3, v1, 2, 2
    v_xor_b32 v3, v3, v2
    v_lshl_add_u32 v200, v3, 6, v200
    v_and_b32 v3, 3, v1
    v_lshl_add_u32 v200, v3, 4, v200
    s_add_u32 s8, s4, s3
    s_and_b32 s8, s8, 6
    s_lshl_b32 s8, s8, 7
    v_add_u32 v200, s8, v200
    s_mov_b32 s20, s40
    s_and_b32 s21, s41, 0xffff
    s_mov_b32 s22, 0x80000
    s_mov_b32 s23, 0x20000
    s_lshl_b32 s8, s5, 10
    s_add_u32 m0, s8, 65536
    s_nop 0
    buffer_load_dwordx4 v200, s[20:23], 0 offen lds
    v_lshlrev_b32 v208, 16, v208
    v_lshlrev_b32 v204, 16, v204
    s_add_u32 s54, s54, s55
    s_add_u32 s54, s54, 98304
    v_mul_f32 v218, v204, v208
    v_mul_f32 v219, v205, v208
    v_lshl_add_u32 v220, v1, 2, s54
    v_mul_f32 v218, 0xbfb8aa3b, v218
    v_mul_f32 v219, 0x3e22f983, v219
    v_mul_f32 v222, 0x41000000, v218
    v_mul_f32 v223, 0x41000000, v219
    v_mul_f32 v224, 0x41800000, v218
    v_mul_f32 v225, 0x41800000, v219
    v_mul_f32 v234, 0x42000000, v218
    v_mul_f32 v235, 0x42000000, v219
    s_add_u32 s8, s35, 6
    s_and_b32 s8, s8, 7
    s_mul_i32 s9, s8, 196608
    s_add_u32 m0, s28, 73728
    s_nop 0
    buffer_load_dwordx4 v8, s[16:19], s9 offen lds
    v_exp_f32 v222, v222
    v_fract_f32 v223, v223
    v_exp_f32 v224, v224
    v_fract_f32 v225, v225
    v_exp_f32 v234, v234
    v_fract_f32 v235, v235
    v_cos_f32 v242, v223
    v_sin_f32 v243, v223
    v_cos_f32 v244, v225
    v_sin_f32 v245, v225
    v_cos_f32 v246, v235
    v_sin_f32 v247, v235
    v_mul_f32 v242, v242, v222
    v_mul_f32 v243, v243, v222
    v_mul_f32 v244, v244, v224
    s_add_u32 s8, s35, 7
    s_and_b32 s8, s8, 7
    s_mul_i32 s9, s8, 196608
    s_add_u32 m0, s28, 81920
    s_nop 0
    buffer_load_dwordx4 v8, s[16:19], s9 offen lds
    v_mul_f32 v245, v245, v224
    v_mul_f32 v246, v246, v234
    v_mul_f32 v247, v247, v234
    v_mov_b32 v226, 1.0
    v_mov_b32 v227, 0
    v_mov_b32 v228, v242
    v_mov_b32 v229, v243
    v_mov_b32 v230, v244
    v_mov_b32 v231, v245
    v_pk_mul_f32 v[234:235], v[242:243], v[244:245] op_sel:[0,0] op_sel_hi:[0,1]
    v_pk_fma_f32 v[232:233], v[242:243], v[244:245], v[234:235] op_sel:[1,1,0] op_sel_hi:[1,0,1] neg_lo:[0,1,0]
    v_pk_mul_f32 v[234:235], v[226:227], v[246:247] op_sel:[0,0] op_sel_hi:[0,1]
    v_pk_mul_f32 v[236:237], v[228:229], v[246:247] op_sel:[0,0] op_sel_hi:[0,1]
    v_pk_mul_f32 v[238:239], v[230:231], v[246:247] op_sel:[0,0] op_sel_hi:[0,1]
    v_pk_mul_f32 v[240:241], v[232:233], v[246:247] op_sel:[0,0] op_sel_hi:[0,1]
    v_cvt_pk_bf16_f32 v222, v226, v227
    s_waitcnt vmcnt(4)
    s_barrier
    s_cmp_lg_u32 s5, 0
    s_cbranch_scc1 concat_heads__softmax_full_mha__ssm_conv_s4d__prompt_kernel_fkv
    s_lshl_b32 s8, s53, 6
    s_add_u32 s8, s8, 14696448
    v_mov_b32 v2, s98
    v_mov_b32 v3, s31
    v_mov_b32 v4, 0
    s_mov_b64 s[10:11], exec
    s_mov_b64 exec, 1
    buffer_store_dwordx2 v[2:3], v4, s[24:27], s8 offen sc1
    s_mov_b64 exec, s[10:11]
concat_heads__softmax_full_mha__ssm_conv_s4d__prompt_kernel_fkv:
    v_cvt_pk_bf16_f32 v223, v228, v229
    v_cvt_pk_bf16_f32 v224, v230, v231
    v_cvt_pk_bf16_f32 v225, v232, v233
    v_pk_fma_f32 v[226:227], v[226:227], v[246:247], v[234:235] op_sel:[1,1,0] op_sel_hi:[1,0,1] neg_lo:[0,1,0]
    v_pk_fma_f32 v[228:229], v[228:229], v[246:247], v[236:237] op_sel:[1,1,0] op_sel_hi:[1,0,1] neg_lo:[0,1,0]
    v_pk_fma_f32 v[230:231], v[230:231], v[246:247], v[238:239] op_sel:[1,1,0] op_sel_hi:[1,0,1] neg_lo:[0,1,0]
    v_pk_fma_f32 v[232:233], v[232:233], v[246:247], v[240:241] op_sel:[1,1,0] op_sel_hi:[1,0,1] neg_lo:[0,1,0]
    ds_write2_b32 v220, v222, v223 offset0:0 offset1:132
    v_add_u32 v221, 1056, v220
    ds_write2_b32 v221, v224, v225 offset0:0 offset1:132
    v_add_u32 v220, 2112, v220
    v_pk_mul_f32 v[234:235], v[226:227], v[246:247] op_sel:[0,0] op_sel_hi:[0,1]
    v_pk_mul_f32 v[236:237], v[228:229], v[246:247] op_sel:[0,0] op_sel_hi:[0,1]
    v_pk_mul_f32 v[238:239], v[230:231], v[246:247] op_sel:[0,0] op_sel_hi:[0,1]
    v_pk_mul_f32 v[240:241], v[232:233], v[246:247] op_sel:[0,0] op_sel_hi:[0,1]
    v_cvt_pk_bf16_f32 v222, v226, v227
    v_cvt_pk_bf16_f32 v223, v228, v229
    v_cvt_pk_bf16_f32 v224, v230, v231
    v_cvt_pk_bf16_f32 v225, v232, v233
    v_pk_fma_f32 v[226:227], v[226:227], v[246:247], v[234:235] op_sel:[1,1,0] op_sel_hi:[1,0,1] neg_lo:[0,1,0]
    v_pk_fma_f32 v[228:229], v[228:229], v[246:247], v[236:237] op_sel:[1,1,0] op_sel_hi:[1,0,1] neg_lo:[0,1,0]
    v_pk_fma_f32 v[230:231], v[230:231], v[246:247], v[238:239] op_sel:[1,1,0] op_sel_hi:[1,0,1] neg_lo:[0,1,0]
    v_pk_fma_f32 v[232:233], v[232:233], v[246:247], v[240:241] op_sel:[1,1,0] op_sel_hi:[1,0,1] neg_lo:[0,1,0]
    ds_write2_b32 v220, v222, v223 offset0:0 offset1:132
    v_add_u32 v221, 1056, v220
    ds_write2_b32 v221, v224, v225 offset0:0 offset1:132
    v_add_u32 v220, 2112, v220
    v_pk_mul_f32 v[234:235], v[226:227], v[246:247] op_sel:[0,0] op_sel_hi:[0,1]
    v_pk_mul_f32 v[236:237], v[228:229], v[246:247] op_sel:[0,0] op_sel_hi:[0,1]
    v_pk_mul_f32 v[238:239], v[230:231], v[246:247] op_sel:[0,0] op_sel_hi:[0,1]
    v_pk_mul_f32 v[240:241], v[232:233], v[246:247] op_sel:[0,0] op_sel_hi:[0,1]
    v_cvt_pk_bf16_f32 v222, v226, v227
    v_cvt_pk_bf16_f32 v223, v228, v229
    v_cvt_pk_bf16_f32 v224, v230, v231
    v_cvt_pk_bf16_f32 v225, v232, v233
    v_pk_fma_f32 v[226:227], v[226:227], v[246:247], v[234:235] op_sel:[1,1,0] op_sel_hi:[1,0,1] neg_lo:[0,1,0]
    v_pk_fma_f32 v[228:229], v[228:229], v[246:247], v[236:237] op_sel:[1,1,0] op_sel_hi:[1,0,1] neg_lo:[0,1,0]
    v_pk_fma_f32 v[230:231], v[230:231], v[246:247], v[238:239] op_sel:[1,1,0] op_sel_hi:[1,0,1] neg_lo:[0,1,0]
    v_pk_fma_f32 v[232:233], v[232:233], v[246:247], v[240:241] op_sel:[1,1,0] op_sel_hi:[1,0,1] neg_lo:[0,1,0]
    ds_write2_b32 v220, v222, v223 offset0:0 offset1:132
    v_add_u32 v221, 1056, v220
    ds_write2_b32 v221, v224, v225 offset0:0 offset1:132
    v_add_u32 v220, 2112, v220
    v_pk_mul_f32 v[234:235], v[226:227], v[246:247] op_sel:[0,0] op_sel_hi:[0,1]
    v_pk_mul_f32 v[236:237], v[228:229], v[246:247] op_sel:[0,0] op_sel_hi:[0,1]
    v_pk_mul_f32 v[238:239], v[230:231], v[246:247] op_sel:[0,0] op_sel_hi:[0,1]
    v_pk_mul_f32 v[240:241], v[232:233], v[246:247] op_sel:[0,0] op_sel_hi:[0,1]
    v_cvt_pk_bf16_f32 v222, v226, v227
    v_cvt_pk_bf16_f32 v223, v228, v229
    v_cvt_pk_bf16_f32 v224, v230, v231
    v_cvt_pk_bf16_f32 v225, v232, v233
    v_pk_fma_f32 v[226:227], v[226:227], v[246:247], v[234:235] op_sel:[1,1,0] op_sel_hi:[1,0,1] neg_lo:[0,1,0]
    v_pk_fma_f32 v[228:229], v[228:229], v[246:247], v[236:237] op_sel:[1,1,0] op_sel_hi:[1,0,1] neg_lo:[0,1,0]
    v_pk_fma_f32 v[230:231], v[230:231], v[246:247], v[238:239] op_sel:[1,1,0] op_sel_hi:[1,0,1] neg_lo:[0,1,0]
    v_pk_fma_f32 v[232:233], v[232:233], v[246:247], v[240:241] op_sel:[1,1,0] op_sel_hi:[1,0,1] neg_lo:[0,1,0]
    ds_write2_b32 v220, v222, v223 offset0:0 offset1:132
    v_add_u32 v221, 1056, v220
    ds_write2_b32 v221, v224, v225 offset0:0 offset1:132
    v_add_u32 v220, 2112, v220
    v_pk_mul_f32 v[234:235], v[226:227], v[246:247] op_sel:[0,0] op_sel_hi:[0,1]
    v_pk_mul_f32 v[236:237], v[228:229], v[246:247] op_sel:[0,0] op_sel_hi:[0,1]
    v_pk_mul_f32 v[238:239], v[230:231], v[246:247] op_sel:[0,0] op_sel_hi:[0,1]
    v_pk_mul_f32 v[240:241], v[232:233], v[246:247] op_sel:[0,0] op_sel_hi:[0,1]
    v_cvt_pk_bf16_f32 v222, v226, v227
    v_cvt_pk_bf16_f32 v223, v228, v229
    v_cvt_pk_bf16_f32 v224, v230, v231
    v_cvt_pk_bf16_f32 v225, v232, v233
    v_pk_fma_f32 v[226:227], v[226:227], v[246:247], v[234:235] op_sel:[1,1,0] op_sel_hi:[1,0,1] neg_lo:[0,1,0]
    v_pk_fma_f32 v[228:229], v[228:229], v[246:247], v[236:237] op_sel:[1,1,0] op_sel_hi:[1,0,1] neg_lo:[0,1,0]
    v_pk_fma_f32 v[230:231], v[230:231], v[246:247], v[238:239] op_sel:[1,1,0] op_sel_hi:[1,0,1] neg_lo:[0,1,0]
    v_pk_fma_f32 v[232:233], v[232:233], v[246:247], v[240:241] op_sel:[1,1,0] op_sel_hi:[1,0,1] neg_lo:[0,1,0]
    ds_write2_b32 v220, v222, v223 offset0:0 offset1:132
    v_add_u32 v221, 1056, v220
    ds_write2_b32 v221, v224, v225 offset0:0 offset1:132
    v_add_u32 v220, 2112, v220
    v_pk_mul_f32 v[234:235], v[226:227], v[246:247] op_sel:[0,0] op_sel_hi:[0,1]
    v_pk_mul_f32 v[236:237], v[228:229], v[246:247] op_sel:[0,0] op_sel_hi:[0,1]
    v_pk_mul_f32 v[238:239], v[230:231], v[246:247] op_sel:[0,0] op_sel_hi:[0,1]
    v_pk_mul_f32 v[240:241], v[232:233], v[246:247] op_sel:[0,0] op_sel_hi:[0,1]
    v_cvt_pk_bf16_f32 v222, v226, v227
    v_cvt_pk_bf16_f32 v223, v228, v229
    v_cvt_pk_bf16_f32 v224, v230, v231
    v_cvt_pk_bf16_f32 v225, v232, v233
    v_pk_fma_f32 v[226:227], v[226:227], v[246:247], v[234:235] op_sel:[1,1,0] op_sel_hi:[1,0,1] neg_lo:[0,1,0]
    v_pk_fma_f32 v[228:229], v[228:229], v[246:247], v[236:237] op_sel:[1,1,0] op_sel_hi:[1,0,1] neg_lo:[0,1,0]
    v_pk_fma_f32 v[230:231], v[230:231], v[246:247], v[238:239] op_sel:[1,1,0] op_sel_hi:[1,0,1] neg_lo:[0,1,0]
    v_pk_fma_f32 v[232:233], v[232:233], v[246:247], v[240:241] op_sel:[1,1,0] op_sel_hi:[1,0,1] neg_lo:[0,1,0]
    ds_write2_b32 v220, v222, v223 offset0:0 offset1:132
    v_add_u32 v221, 1056, v220
    ds_write2_b32 v221, v224, v225 offset0:0 offset1:132
    v_add_u32 v220, 2112, v220
    v_pk_mul_f32 v[234:235], v[226:227], v[246:247] op_sel:[0,0] op_sel_hi:[0,1]
    v_pk_mul_f32 v[236:237], v[228:229], v[246:247] op_sel:[0,0] op_sel_hi:[0,1]
    v_pk_mul_f32 v[238:239], v[230:231], v[246:247] op_sel:[0,0] op_sel_hi:[0,1]
    v_pk_mul_f32 v[240:241], v[232:233], v[246:247] op_sel:[0,0] op_sel_hi:[0,1]
    v_cvt_pk_bf16_f32 v222, v226, v227
    v_cvt_pk_bf16_f32 v223, v228, v229
    v_cvt_pk_bf16_f32 v224, v230, v231
    v_cvt_pk_bf16_f32 v225, v232, v233
    v_pk_fma_f32 v[226:227], v[226:227], v[246:247], v[234:235] op_sel:[1,1,0] op_sel_hi:[1,0,1] neg_lo:[0,1,0]
    v_pk_fma_f32 v[228:229], v[228:229], v[246:247], v[236:237] op_sel:[1,1,0] op_sel_hi:[1,0,1] neg_lo:[0,1,0]
    v_pk_fma_f32 v[230:231], v[230:231], v[246:247], v[238:239] op_sel:[1,1,0] op_sel_hi:[1,0,1] neg_lo:[0,1,0]
    v_pk_fma_f32 v[232:233], v[232:233], v[246:247], v[240:241] op_sel:[1,1,0] op_sel_hi:[1,0,1] neg_lo:[0,1,0]
    ds_write2_b32 v220, v222, v223 offset0:0 offset1:132
    v_add_u32 v221, 1056, v220
    ds_write2_b32 v221, v224, v225 offset0:0 offset1:132
    v_add_u32 v220, 2112, v220
    v_cvt_pk_bf16_f32 v222, v226, v227
    v_cvt_pk_bf16_f32 v223, v228, v229
    v_cvt_pk_bf16_f32 v224, v230, v231
    v_cvt_pk_bf16_f32 v225, v232, v233
    ds_write2_b32 v220, v222, v223 offset0:0 offset1:132
    v_add_u32 v221, 1056, v220
    ds_write2_b32 v221, v224, v225 offset0:0 offset1:132
    s_cmp_eq_u32 s5, 0
    s_cbranch_scc1 concat_heads__softmax_full_mha__ssm_conv_s4d__prompt_kernel_wq0
    s_waitcnt vmcnt(0)
    s_branch concat_heads__softmax_full_mha__ssm_conv_s4d__prompt_kernel_wq1
concat_heads__softmax_full_mha__ssm_conv_s4d__prompt_kernel_wq0:
    s_waitcnt vmcnt(1)
concat_heads__softmax_full_mha__ssm_conv_s4d__prompt_kernel_wq1:
    v_lshrrev_b32 v2, 3, v0
    v_mul_u32_u24 v2, 132, v2
    v_and_b32 v3, 7, v0
    v_lshl_add_u32 v2, v3, 4, v2
    v_add_u32 v2, 154272, v2
    ds_write_b32 v2, v10 offset:0
    ds_write_b32 v2, v11 offset:4
    ds_write_b32 v2, v12 offset:8
    ds_write_b32 v2, v13 offset:12
    s_waitcnt lgkmcnt(0)
    s_barrier
    v_and_b32 v2, 7, v0
    v_mul_u32_u24 v2, 1056, v2
    v_lshrrev_b32 v3, 3, v0
    v_lshl_add_u32 v2, v3, 1, v2
    v_add_u32 v2, 154272, v2
    ds_read_u16_d16 v192, v2 offset:0
    ds_read_u16_d16_hi v193, v2 offset:132
    ds_read_u16_d16 v194, v2 offset:264
    ds_read_u16_d16_hi v195, v2 offset:396
    ds_read_u16_d16 v196, v2 offset:528
    ds_read_u16_d16_hi v197, v2 offset:660
    ds_read_u16_d16 v198, v2 offset:792
    ds_read_u16_d16_hi v199, v2 offset:924
    v_bfe_u32 v2, v1, 2, 2
    v_lshrrev_b32 v3, 5, v1
    v_lshl_add_u32 v3, v3, 2, v2
    v_xor_b32 v5, s5, v2
    v_lshlrev_b32 v5, 6, v5
    v_lshl_add_u32 v5, v3, 8, v5
    v_bfe_u32 v4, v1, 4, 1
    v_lshl_add_u32 v5, v4, 5, v5
    v_and_b32 v4, 3, v1
    v_lshl_add_u32 v5, v4, 3, v5
    v_add_u32 v5, 65536, v5
    ds_read_b64_tr_b16 v[200:201], v5
    ds_read_b64_tr_b16 v[202:203], v5 offset:2048
    ds_read_b64_tr_b16 v[64:65], v24 offset:0
    ds_read_b64_tr_b16 v[66:67], v24 offset:512
    ds_read_b64_tr_b16 v[68:69], v24 offset:2048
    ds_read_b64_tr_b16 v[70:71], v24 offset:2560
    ds_read_b64_tr_b16 v[72:73], v24 offset:4096
    ds_read_b64_tr_b16 v[74:75], v24 offset:4608
    ds_read_b64_tr_b16 v[76:77], v24 offset:6144
    ds_read_b64_tr_b16 v[78:79], v24 offset:6656
    ds_read_b64_tr_b16 v[80:81], v24 offset:8192
    ds_read_b64_tr_b16 v[82:83], v24 offset:8704
    ds_read_b64_tr_b16 v[84:85], v24 offset:10240
    ds_read_b64_tr_b16 v[86:87], v24 offset:10752
    ds_read_b64_tr_b16 v[88:89], v24 offset:12288
    ds_read_b64_tr_b16 v[90:91], v24 offset:12800
    ds_read_b64_tr_b16 v[92:93], v24 offset:14336
    ds_read_b64_tr_b16 v[94:95], v24 offset:14848
    s_waitcnt lgkmcnt(14)
    v_mfma_f32_32x32x16_bf16 v[48:63], v[64:67], v[128:131], 0
    s_waitcnt lgkmcnt(12)
    v_mfma_f32_32x32x16_bf16 v[48:63], v[68:71], v[132:135], v[48:63]
    s_waitcnt lgkmcnt(10)
    v_mfma_f32_32x32x16_bf16 v[48:63], v[72:75], v[136:139], v[48:63]
    s_waitcnt lgkmcnt(8)
    v_mfma_f32_32x32x16_bf16 v[48:63], v[76:79], v[140:143], v[48:63]
    s_waitcnt lgkmcnt(6)
    v_mfma_f32_32x32x16_bf16 v[48:63], v[80:83], v[144:147], v[48:63]
    s_waitcnt lgkmcnt(4)
    v_mfma_f32_32x32x16_bf16 v[48:63], v[84:87], v[148:151], v[48:63]
    s_waitcnt lgkmcnt(2)
    v_mfma_f32_32x32x16_bf16 v[48:63], v[88:91], v[152:155], v[48:63]
    s_waitcnt lgkmcnt(0)
    v_mfma_f32_32x32x16_bf16 v[48:63], v[92:95], v[156:159], v[48:63]
    ds_read_b64_tr_b16 v[64:65], v24 offset:24576
    ds_read_b64_tr_b16 v[66:67], v24 offset:25088
    ds_read_b64_tr_b16 v[68:69], v24 offset:26624
    ds_read_b64_tr_b16 v[70:71], v24 offset:27136
    ds_read_b64_tr_b16 v[72:73], v24 offset:28672
    ds_read_b64_tr_b16 v[74:75], v24 offset:29184
    ds_read_b64_tr_b16 v[76:77], v24 offset:30720
    ds_read_b64_tr_b16 v[78:79], v24 offset:31232
    ds_read_b64_tr_b16 v[80:81], v24 offset:32768
    ds_read_b64_tr_b16 v[82:83], v24 offset:33280
    ds_read_b64_tr_b16 v[84:85], v24 offset:34816
    ds_read_b64_tr_b16 v[86:87], v24 offset:35328
    ds_read_b64_tr_b16 v[88:89], v24 offset:36864
    ds_read_b64_tr_b16 v[90:91], v24 offset:37376
    ds_read_b64_tr_b16 v[92:93], v24 offset:38912
    ds_read_b64_tr_b16 v[94:95], v24 offset:39424
    s_add_u32 s8, s4, s3
    s_and_b32 s8, s8, 7
    s_lshl_b32 s8, s8, 6
    v_lshrrev_b32 v3, 3, v0
    v_add_u32 v3, s8, v3
    v_lshlrev_b32 v3, 12, v3
    v_and_b32 v4, 7, v0
    v_lshl_add_u32 v3, v4, 4, v3
    s_lshl_b32 s8, s3, 7
    s_add_u32 s8, s8, 6291456
    v_or_b32 v10, v192, v193
    v_or_b32 v11, v194, v195
    v_or_b32 v12, v196, v197
    v_or_b32 v13, v198, v199
    buffer_store_dwordx4 v[10:13], v3, s[24:27], s8 offen sc1
    s_add_u32 s8, s4, s3
    s_and_b32 s8, s8, 7
    s_lshl_b32 s8, s8, 5
    s_add_u32 s8, s8, s3
    s_lshl_b32 s8, s8, 2
    s_add_u32 s8, s8, s5
    s_lshl_b32 s8, s8, 10
    s_add_u32 s8, s8, 4194304
    v_lshlrev_b32 v2, 4, v1
    buffer_store_dwordx4 v[200:203], v2, s[24:27], s8 offen sc1
    s_getpc_b64 s[56:57]
concat_heads__softmax_full_mha__ssm_conv_s4d__prompt_kernel_k_pc:
    s_add_u32 s56, s56, concat_heads__softmax_full_mha__ssm_conv_s4d__prompt_kernel_idx-concat_heads__softmax_full_mha__ssm_conv_s4d__prompt_kernel_k_pc
    s_addc_u32 s57, s57, 0
    v_and_b32 v2, 255, v0
    v_mul_u32_u24 v2, 24, v2
    global_load_dwordx2 v[212:213], v2, s[56:57]
    global_load_dwordx4 v[214:217], v2, s[56:57] offset:8
    s_waitcnt lgkmcnt(14)
    v_mfma_f32_32x32x16_bf16 v[48:63], v[64:67], v[160:163], v[48:63]
    s_waitcnt lgkmcnt(12)
    v_mfma_f32_32x32x16_bf16 v[48:63], v[68:71], v[164:167], v[48:63]
    s_waitcnt lgkmcnt(10)
    v_mfma_f32_32x32x16_bf16 v[48:63], v[72:75], v[168:171], v[48:63]
    s_waitcnt lgkmcnt(8)
    v_mfma_f32_32x32x16_bf16 v[48:63], v[76:79], v[172:175], v[48:63]
    s_waitcnt lgkmcnt(6)
    v_mfma_f32_32x32x16_bf16 v[48:63], v[80:83], v[176:179], v[48:63]
    s_waitcnt lgkmcnt(4)
    v_mfma_f32_32x32x16_bf16 v[48:63], v[84:87], v[180:183], v[48:63]
    s_waitcnt lgkmcnt(2)
    v_mfma_f32_32x32x16_bf16 v[48:63], v[88:91], v[184:187], v[48:63]
    s_waitcnt lgkmcnt(0)
    v_mfma_f32_32x32x16_bf16 v[48:63], v[92:95], v[188:191], v[48:63]
    s_branch concat_heads__softmax_full_mha__ssm_conv_s4d__prompt_kernel_g1
concat_heads__softmax_full_mha__ssm_conv_s4d__prompt_kernel_v:
    s_waitcnt vmcnt(6) lgkmcnt(0)
    s_barrier
    ds_read_b128 v[64:67], v14 offset:0
    ds_read_b64_tr_b16 v[96:97], v22 offset:0
    ds_read_b64_tr_b16 v[98:99], v22 offset:1024
    s_add_u32 s8, s35, 3
    s_and_b32 s8, s8, 7
    s_mul_i32 s9, s8, 196608
    s_lshl_b32 s8, s8, 7
    s_add_u32 m0, s28, 73728
    s_add_u32 s10, s9, 12288
    buffer_load_dwordx4 v6, s[12:15], s8 offen lds
    ds_read_b128 v[68:71], v15 offset:0
    ds_read_b64_tr_b16 v[100:101], v22 offset:4096
    ds_read_b64_tr_b16 v[102:103], v22 offset:5120
    s_add_u32 m0, s29, 73728
    s_nop 0
    buffer_load_dwordx4 v7, s[16:19], s9 offen lds
    ds_read_b128 v[72:75], v16 offset:0
    ds_read_b64_tr_b16 v[104:105], v22 offset:8192
    ds_read_b64_tr_b16 v[106:107], v22 offset:9216
    s_add_u32 m0, s29, 74752
    s_nop 0
    buffer_load_dwordx4 v7, s[16:19], s10 offen lds
    ds_read_b128 v[76:79], v17 offset:0
    ds_read_b64_tr_b16 v[108:109], v22 offset:12288
    ds_read_b64_tr_b16 v[110:111], v22 offset:13312
    s_waitcnt vmcnt(6) lgkmcnt(0)
    s_barrier
    ds_read_b128 v[112:115], v14 offset:24576
    ds_read_b64_tr_b16 v[80:81], v22 offset:24576
    ds_read_b64_tr_b16 v[82:83], v22 offset:25600
    v_mfma_f32_32x32x16_bf16 v[32:47], v[64:67], v[96:99], v[32:47]
    s_add_u32 s8, s35, 4
    s_and_b32 s8, s8, 7
    s_mul_i32 s9, s8, 196608
    s_lshl_b32 s8, s8, 7
    s_add_u32 m0, s28, 0
    s_add_u32 s10, s9, 12288
    buffer_load_dwordx4 v6, s[12:15], s8 offen lds
    ds_read_b128 v[116:119], v15 offset:24576
    ds_read_b64_tr_b16 v[84:85], v22 offset:28672
    ds_read_b64_tr_b16 v[86:87], v22 offset:29696
    v_mfma_f32_32x32x16_bf16 v[32:47], v[68:71], v[100:103], v[32:47]
    s_add_u32 m0, s29, 0
    s_nop 0
    buffer_load_dwordx4 v7, s[16:19], s9 offen lds
    ds_read_b128 v[120:123], v16 offset:24576
    ds_read_b64_tr_b16 v[88:89], v22 offset:32768
    ds_read_b64_tr_b16 v[90:91], v22 offset:33792
    v_mfma_f32_32x32x16_bf16 v[32:47], v[72:75], v[104:107], v[32:47]
    s_add_u32 m0, s29, 1024
    s_nop 0
    buffer_load_dwordx4 v7, s[16:19], s10 offen lds
    ds_read_b128 v[124:127], v17 offset:24576
    ds_read_b64_tr_b16 v[92:93], v22 offset:36864
    ds_read_b64_tr_b16 v[94:95], v22 offset:37888
    v_mfma_f32_32x32x16_bf16 v[32:47], v[76:79], v[108:111], v[32:47]
    s_waitcnt vmcnt(6) lgkmcnt(0)
    s_barrier
    ds_read_b128 v[64:67], v18 offset:0
    ds_read_b64_tr_b16 v[96:97], v23 offset:0
    ds_read_b64_tr_b16 v[98:99], v23 offset:1024
    v_mfma_f32_32x32x16_bf16 v[32:47], v[112:115], v[80:83], v[32:47]
    s_add_u32 s8, s35, 5
    s_and_b32 s8, s8, 7
    s_mul_i32 s9, s8, 196608
    s_lshl_b32 s8, s8, 7
    s_add_u32 m0, s28, 24576
    s_add_u32 s10, s9, 12288
    buffer_load_dwordx4 v6, s[12:15], s8 offen lds
    ds_read_b128 v[68:71], v19 offset:0
    ds_read_b64_tr_b16 v[100:101], v23 offset:4096
    ds_read_b64_tr_b16 v[102:103], v23 offset:5120
    v_mfma_f32_32x32x16_bf16 v[32:47], v[116:119], v[84:87], v[32:47]
    s_add_u32 m0, s29, 24576
    s_nop 0
    buffer_load_dwordx4 v7, s[16:19], s9 offen lds
    ds_read_b128 v[72:75], v20 offset:0
    ds_read_b64_tr_b16 v[104:105], v23 offset:8192
    ds_read_b64_tr_b16 v[106:107], v23 offset:9216
    v_mfma_f32_32x32x16_bf16 v[32:47], v[120:123], v[88:91], v[32:47]
    s_add_u32 m0, s29, 25600
    s_nop 0
    buffer_load_dwordx4 v7, s[16:19], s10 offen lds
    ds_read_b128 v[76:79], v21 offset:0
    ds_read_b64_tr_b16 v[108:109], v23 offset:12288
    ds_read_b64_tr_b16 v[110:111], v23 offset:13312
    v_mfma_f32_32x32x16_bf16 v[32:47], v[124:127], v[92:95], v[32:47]
    s_waitcnt vmcnt(6) lgkmcnt(0)
    s_barrier
    ds_read_b128 v[112:115], v18 offset:24576
    ds_read_b64_tr_b16 v[80:81], v23 offset:24576
    ds_read_b64_tr_b16 v[82:83], v23 offset:25600
    v_mfma_f32_32x32x16_bf16 v[32:47], v[64:67], v[96:99], v[32:47]
    s_add_u32 s8, s35, 6
    s_and_b32 s8, s8, 7
    s_mul_i32 s9, s8, 196608
    s_lshl_b32 s8, s8, 7
    s_add_u32 m0, s28, 49152
    s_add_u32 s10, s9, 12288
    buffer_load_dwordx4 v6, s[12:15], s8 offen lds
    ds_read_b128 v[116:119], v19 offset:24576
    ds_read_b64_tr_b16 v[84:85], v23 offset:28672
    ds_read_b64_tr_b16 v[86:87], v23 offset:29696
    v_mfma_f32_32x32x16_bf16 v[32:47], v[68:71], v[100:103], v[32:47]
    s_add_u32 m0, s29, 49152
    s_nop 0
    buffer_load_dwordx4 v7, s[16:19], s9 offen lds
    ds_read_b128 v[120:123], v20 offset:24576
    ds_read_b64_tr_b16 v[88:89], v23 offset:32768
    ds_read_b64_tr_b16 v[90:91], v23 offset:33792
    v_mfma_f32_32x32x16_bf16 v[32:47], v[72:75], v[104:107], v[32:47]
    s_add_u32 m0, s29, 50176
    s_nop 0
    buffer_load_dwordx4 v7, s[16:19], s10 offen lds
    ds_read_b128 v[124:127], v21 offset:24576
    ds_read_b64_tr_b16 v[92:93], v23 offset:36864
    ds_read_b64_tr_b16 v[94:95], v23 offset:37888
    v_mfma_f32_32x32x16_bf16 v[32:47], v[76:79], v[108:111], v[32:47]
    s_waitcnt vmcnt(6) lgkmcnt(0)
    s_barrier
    ds_read_b128 v[128:131], v14 offset:0
    ds_read_b64_tr_b16 v[96:97], v22 offset:0
    ds_read_b64_tr_b16 v[98:99], v22 offset:1024
    v_mfma_f32_32x32x16_bf16 v[32:47], v[112:115], v[80:83], v[32:47]
    s_add_u32 s8, s35, 7
    s_and_b32 s8, s8, 7
    s_mul_i32 s9, s8, 196608
    s_lshl_b32 s8, s8, 7
    s_add_u32 m0, s28, 73728
    s_add_u32 s10, s9, 12288
    buffer_load_dwordx4 v6, s[12:15], s8 offen lds
    ds_read_b128 v[132:135], v15 offset:0
    ds_read_b64_tr_b16 v[100:101], v22 offset:4096
    ds_read_b64_tr_b16 v[102:103], v22 offset:5120
    v_mfma_f32_32x32x16_bf16 v[32:47], v[116:119], v[84:87], v[32:47]
    s_add_u32 m0, s29, 73728
    s_nop 0
    buffer_load_dwordx4 v7, s[16:19], s9 offen lds
    ds_read_b128 v[136:139], v16 offset:0
    ds_read_b64_tr_b16 v[104:105], v22 offset:8192
    ds_read_b64_tr_b16 v[106:107], v22 offset:9216
    v_mfma_f32_32x32x16_bf16 v[32:47], v[120:123], v[88:91], v[32:47]
    s_add_u32 m0, s29, 74752
    s_nop 0
    buffer_load_dwordx4 v7, s[16:19], s10 offen lds
    ds_read_b128 v[140:143], v17 offset:0
    ds_read_b64_tr_b16 v[108:109], v22 offset:12288
    ds_read_b64_tr_b16 v[110:111], v22 offset:13312
    v_mfma_f32_32x32x16_bf16 v[32:47], v[124:127], v[92:95], v[32:47]
    s_waitcnt vmcnt(6) lgkmcnt(0)
    s_barrier
    ds_read_b128 v[144:147], v14 offset:24576
    ds_read_b64_tr_b16 v[80:81], v22 offset:24576
    ds_read_b64_tr_b16 v[82:83], v22 offset:25600
    v_mfma_f32_32x32x16_bf16 v[32:47], v[128:131], v[96:99], v[32:47]
    s_add_u32 s8, s35, 0
    s_and_b32 s8, s8, 7
    s_mul_i32 s9, s8, 196608
    s_add_u32 m0, s28, 0
    s_nop 0
    buffer_load_dwordx4 v8, s[16:19], s9 offen lds
    ds_read_b128 v[148:151], v15 offset:24576
    ds_read_b64_tr_b16 v[84:85], v22 offset:28672
    ds_read_b64_tr_b16 v[86:87], v22 offset:29696
    v_mfma_f32_32x32x16_bf16 v[32:47], v[132:135], v[100:103], v[32:47]
    s_add_u32 s8, s35, 1
    s_and_b32 s8, s8, 7
    s_mul_i32 s9, s8, 196608
    s_add_u32 m0, s28, 8192
    s_nop 0
    buffer_load_dwordx4 v8, s[16:19], s9 offen lds
    ds_read_b128 v[152:155], v16 offset:24576
    ds_read_b64_tr_b16 v[88:89], v22 offset:32768
    ds_read_b64_tr_b16 v[90:91], v22 offset:33792
    v_mfma_f32_32x32x16_bf16 v[32:47], v[136:139], v[104:107], v[32:47]
    ds_read_b128 v[156:159], v17 offset:24576
    ds_read_b64_tr_b16 v[92:93], v22 offset:36864
    ds_read_b64_tr_b16 v[94:95], v22 offset:37888
    v_mfma_f32_32x32x16_bf16 v[32:47], v[140:143], v[108:111], v[32:47]
    v_mov_b32 v30, 14745600
    buffer_load_dwordx2 v[28:29], v30, s[24:27], 0 offen sc1
    s_lshl_b32 s50, s4, 6
    s_lshl_b32 s51, s3, 1
    s_add_u32 s50, s50, s51
    s_and_b32 s51, s5, 1
    s_add_u32 s51, s50, s51
    s_lshl_b32 s52, s51, 8
    s_bfe_u32 s53, s5, 0x10001
    s_lshl_b32 s53, s53, 7
    s_add_u32 s52, s52, s53
    s_lshl_b32 s53, s51, 1
    v_lshl_add_u32 v210, v1, 1, s52
    v_mov_b32 v211, s53
    global_load_ushort v204, v210, s[44:45]
    global_load_ushort v205, v210, s[46:47]
    global_load_ushort v206, v210, s[48:49]
    global_load_ushort v207, v210, s[60:61]
    global_load_ushort v208, v211, s[62:63]
    global_load_ushort v209, v211, s[64:65]
    s_lshr_b32 s50, s5, 2
    s_bfe_u32 s51, s5, 0x10001
    s_and_b32 s52, s5, 1
    s_lshl_b32 s53, s4, 5
    s_add_u32 s53, s53, s3
    s_waitcnt vmcnt(12) lgkmcnt(0)
    s_barrier
    ds_read_b128 v[160:163], v18 offset:0
    ds_read_b64_tr_b16 v[96:97], v23 offset:0
    ds_read_b64_tr_b16 v[98:99], v23 offset:1024
    v_mfma_f32_32x32x16_bf16 v[32:47], v[144:147], v[80:83], v[32:47]
    s_add_u32 s8, s35, 2
    s_and_b32 s8, s8, 7
    s_mul_i32 s9, s8, 196608
    s_add_u32 m0, s28, 24576
    s_nop 0
    buffer_load_dwordx4 v8, s[16:19], s9 offen lds
    ds_read_b128 v[164:167], v19 offset:0
    ds_read_b64_tr_b16 v[100:101], v23 offset:4096
    ds_read_b64_tr_b16 v[102:103], v23 offset:5120
    v_mfma_f32_32x32x16_bf16 v[32:47], v[148:151], v[84:87], v[32:47]
    s_add_u32 s8, s35, 3
    s_and_b32 s8, s8, 7
    s_mul_i32 s9, s8, 196608
    s_add_u32 m0, s28, 32768
    s_nop 0
    buffer_load_dwordx4 v8, s[16:19], s9 offen lds
    ds_read_b128 v[168:171], v20 offset:0
    ds_read_b64_tr_b16 v[104:105], v23 offset:8192
    ds_read_b64_tr_b16 v[106:107], v23 offset:9216
    v_mfma_f32_32x32x16_bf16 v[32:47], v[152:155], v[88:91], v[32:47]
    ds_read_b128 v[172:175], v21 offset:0
    ds_read_b64_tr_b16 v[108:109], v23 offset:12288
    ds_read_b64_tr_b16 v[110:111], v23 offset:13312
    v_mfma_f32_32x32x16_bf16 v[32:47], v[156:159], v[92:95], v[32:47]
    s_waitcnt vmcnt(11) lgkmcnt(0)
    s_barrier
    ds_read_b128 v[176:179], v18 offset:24576
    ds_read_b64_tr_b16 v[80:81], v23 offset:24576
    ds_read_b64_tr_b16 v[82:83], v23 offset:25600
    v_mfma_f32_32x32x16_bf16 v[32:47], v[160:163], v[96:99], v[32:47]
    s_add_u32 s8, s35, 4
    s_and_b32 s8, s8, 7
    s_mul_i32 s9, s8, 196608
    s_add_u32 m0, s28, 49152
    s_nop 0
    buffer_load_dwordx4 v8, s[16:19], s9 offen lds
    ds_read_b128 v[180:183], v19 offset:24576
    ds_read_b64_tr_b16 v[84:85], v23 offset:28672
    ds_read_b64_tr_b16 v[86:87], v23 offset:29696
    v_mfma_f32_32x32x16_bf16 v[32:47], v[164:167], v[100:103], v[32:47]
    s_add_u32 s8, s35, 5
    s_and_b32 s8, s8, 7
    s_mul_i32 s9, s8, 196608
    s_add_u32 m0, s28, 57344
    s_nop 0
    buffer_load_dwordx4 v8, s[16:19], s9 offen lds
    ds_read_b128 v[184:187], v20 offset:24576
    ds_read_b64_tr_b16 v[88:89], v23 offset:32768
    ds_read_b64_tr_b16 v[90:91], v23 offset:33792
    v_mfma_f32_32x32x16_bf16 v[32:47], v[168:171], v[104:107], v[32:47]
    ds_read_b128 v[188:191], v21 offset:24576
    ds_read_b64_tr_b16 v[92:93], v23 offset:36864
    ds_read_b64_tr_b16 v[94:95], v23 offset:37888
    v_mfma_f32_32x32x16_bf16 v[32:47], v[172:175], v[108:111], v[32:47]
    s_waitcnt lgkmcnt(0)
    v_mfma_f32_32x32x16_bf16 v[32:47], v[176:179], v[80:83], v[32:47]
    v_mfma_f32_32x32x16_bf16 v[32:47], v[180:183], v[84:87], v[32:47]
    v_mfma_f32_32x32x16_bf16 v[32:47], v[184:187], v[88:91], v[32:47]
    v_mfma_f32_32x32x16_bf16 v[32:47], v[188:191], v[92:95], v[32:47]
    s_lshl_b32 s8, s4, 2
    s_lshl_b32 s9, s52, 1
    s_add_u32 s8, s8, s9
    s_lshl_b32 s8, s8, 1
    s_add_u32 s8, s8, s51
    s_lshl_b32 s10, s8, 16
    s_lshl_b32 s9, s3, 11
    s_add_u32 s10, s10, s9
    s_nop 3
    v_cvt_pk_bf16_f32 v64, v32, v33
    v_cvt_pk_bf16_f32 v65, v34, v35
    v_cvt_pk_bf16_f32 v66, v36, v37
    v_cvt_pk_bf16_f32 v67, v38, v39
    v_cvt_pk_bf16_f32 v68, v40, v41
    v_cvt_pk_bf16_f32 v69, v42, v43
    v_cvt_pk_bf16_f32 v70, v44, v45
    v_cvt_pk_bf16_f32 v71, v46, v47
    v_bfe_u32 v2, v1, 4, 1
    v_lshlrev_b32 v2, 17, v2
    v_lshrrev_b32 v3, 5, v1
    v_lshl_add_u32 v2, v3, 8, v2
    v_and_b32 v3, 15, v1
    v_lshl_add_u32 v2, v3, 4, v2
    buffer_store_dwordx4 v[64:67], v2, s[24:27], s10 offen offset:1024 sc1
    buffer_store_dwordx4 v[68:71], v2, s[24:27], s10 offen offset:1536 sc1
    v_mov_b32 v76, 0
    v_mov_b32 v77, 0
    v_dot2_f32_bf16 v76, v64, v64, v76
    v_dot2_f32_bf16 v77, v68, v68, v77
    v_dot2_f32_bf16 v76, v65, v65, v76
    v_dot2_f32_bf16 v77, v69, v69, v77
    v_dot2_f32_bf16 v76, v66, v66, v76
    v_dot2_f32_bf16 v77, v70, v70, v77
    v_dot2_f32_bf16 v76, v67, v67, v76
    v_dot2_f32_bf16 v77, v71, v71, v77
    s_nop 2
    v_add_f32 v76, v76, v77
    v_mov_b32 v77, 0x62800000
    v_cmp_nle_f32 vcc, v76, v77
    s_nop 0
    s_cmp_eq_u64 vcc, 0
    s_cbranch_scc1 concat_heads__softmax_full_mha__ssm_conv_s4d__prompt_kernel_nb_v
    v_mov_b32 v2, 163600
    v_mov_b32 v3, 1
    ds_write_b32 v2, v3
concat_heads__softmax_full_mha__ssm_conv_s4d__prompt_kernel_nb_v:
    s_waitcnt vmcnt(6)
    v_readfirstlane_b32 s98, v28
    v_readfirstlane_b32 s99, v29
    s_mul_i32 s98, s98, 0x9E3779B1
    s_add_u32 s98, s98, 0x7F4A7C15
    s_mul_i32 s99, s99, 0x85EBCA6D
    s_add_u32 s99, s99, 0x165667B1
    s_and_b32 s99, s99, 0xfffffffe
    s_waitcnt lgkmcnt(0)
    s_barrier
    s_lshl_b32 s49, s4, 5
    buffer_load_dwordx4 v[10:13], v9, s[20:23], 0 offen
    v_lshlrev_b32 v204, 16, v204
    v_lshlrev_b32 v205, 16, v205
    v_lshlrev_b32 v206, 16, v206
    v_lshlrev_b32 v207, 16, v207
    v_lshlrev_b32 v208, 16, v208
    v_mul_f32 v208, 0x3fb8aa3b, v208
    v_mul_f32 v204, 0x3fb8aa3b, v204
    v_exp_f32 v208, v208
    v_exp_f32 v204, v204
    s_and_b32 s54, s5, 1
    s_mul_i32 s54, s54, 11088
    v_cvt_pk_bf16_f32 v208, v208, v208
    v_cvt_pk_bf16_f32 v204, v204, v204
    s_bfe_u32 s55, s5, 0x10001
    s_lshl_b32 s55, s55, 8
    v_lshlrev_b32 v208, 16, v208
    v_lshlrev_b32 v204, 16, v204
    s_add_u32 s8, s35, 6
    s_and_b32 s8, s8, 7
    s_mul_i32 s9, s8, 196608
    s_add_u32 m0, s28, 73728
    s_nop 0
    buffer_load_dwordx4 v8, s[16:19], s9 offen lds
    s_add_u32 s54, s54, s55
    s_add_u32 s54, s54, 132096
    v_mul_f32 v218, v204, v208
    v_mul_f32 v219, v205, v208
    v_lshl_add_u32 v220, v1, 2, s54
    v_mul_f32 v218, 0xbfb8aa3b, v218
    v_mul_f32 v219, 0x3e22f983, v219
    v_mul_f32 v222, 0x3f800000, v218
    v_mul_f32 v223, 0x3f800000, v219
    v_mul_f32 v224, 0x43800000, v218
    v_mul_f32 v225, 0x43800000, v219
    v_mul_f32 v234, 0x44000000, v218
    v_mul_f32 v235, 0x44000000, v219
    v_mul_f32 v236, 0x44800000, v218
    v_mul_f32 v237, 0x44800000, v219
    v_exp_f32 v222, v222
    v_fract_f32 v223, v223
    s_add_u32 s8, s35, 7
    s_and_b32 s8, s8, 7
    s_mul_i32 s9, s8, 196608
    s_add_u32 m0, s28, 81920
    s_nop 0
    buffer_load_dwordx4 v8, s[16:19], s9 offen lds
    v_exp_f32 v224, v224
    v_fract_f32 v225, v225
    v_exp_f32 v234, v234
    v_fract_f32 v235, v235
    v_exp_f32 v236, v236
    v_fract_f32 v237, v237
    v_cos_f32 v242, v223
    v_sin_f32 v243, v223
    v_cos_f32 v244, v225
    v_sin_f32 v245, v225
    v_cos_f32 v246, v235
    v_sin_f32 v247, v235
    v_cos_f32 v248, v237
    v_sin_f32 v249, v237
    v_mul_f32 v242, v242, v222
    v_mul_f32 v243, v243, v222
    v_mul_f32 v244, v244, v224
    s_waitcnt vmcnt(3)
    s_barrier
    v_mul_f32 v245, v245, v224
    v_mul_f32 v246, v246, v234
    v_mul_f32 v247, v247, v234
    v_mul_f32 v248, v248, v236
    v_mul_f32 v249, v249, v236
    v_mul_f32 v254, v206, v208
    v_mul_f32 v255, v207, v208
    v_pk_mul_f32 v[234:235], v[242:243], v[242:243] op_sel:[0,0] op_sel_hi:[0,1]
    v_pk_fma_f32 v[250:251], v[242:243], v[242:243], v[234:235] op_sel:[1,1,0] op_sel_hi:[1,0,1] neg_lo:[0,1,0]
    v_add_f32 v254, v254, v254
    v_add_f32 v255, v255, v255
    v_pk_mul_f32 v[234:235], v[254:255], v[242:243] op_sel:[0,0] op_sel_hi:[0,1]
    v_pk_mul_f32 v[236:237], v[254:255], v[244:245] op_sel:[0,0] op_sel_hi:[0,1]
    v_pk_mul_f32 v[238:239], v[254:255], v[246:247] op_sel:[0,0] op_sel_hi:[0,1]
    v_pk_mul_f32 v[240:241], v[254:255], v[248:249] op_sel:[0,0] op_sel_hi:[0,1]
    v_pk_fma_f32 v[226:227], v[254:255], v[242:243], v[234:235] op_sel:[1,1,0] op_sel_hi:[1,0,1] neg_lo:[0,1,0]
    v_pk_fma_f32 v[228:229], v[254:255], v[244:245], v[236:237] op_sel:[1,1,0] op_sel_hi:[1,0,1] neg_lo:[0,1,0]
    v_pk_fma_f32 v[230:231], v[254:255], v[246:247], v[238:239] op_sel:[1,1,0] op_sel_hi:[1,0,1] neg_lo:[0,1,0]
    v_pk_fma_f32 v[232:233], v[254:255], v[248:249], v[240:241] op_sel:[1,1,0] op_sel_hi:[1,0,1] neg_lo:[0,1,0]
    v_cvt_pk_bf16_f32 v222, v254, -v255
    ds_write_b32 v220, v222 offset:0
    v_pk_mul_f32 v[234:235], v[250:251], v[250:251] op_sel:[0,0] op_sel_hi:[0,1]
    v_pk_fma_f32 v[252:253], v[250:251], v[250:251], v[234:235] op_sel:[1,1,0] op_sel_hi:[1,0,1] neg_lo:[0,1,0]
    v_cvt_pk_bf16_f32 v222, v226, -v227
    v_cvt_pk_bf16_f32 v223, v228, -v229
    v_cvt_pk_bf16_f32 v224, v230, -v231
    v_cvt_pk_bf16_f32 v225, v232, -v233
    ds_write_b32 v220, v222 offset:528
    ds_write_b32 v220, v223 offset:4224
    ds_write_b32 v220, v224 offset:6336
    ds_write_b32 v220, v225 offset:8448
    v_pk_mul_f32 v[238:239], v[230:231], v[252:253] op_sel:[0,0] op_sel_hi:[0,1]
    v_pk_fma_f32 v[218:219], v[230:231], v[252:253], v[238:239] op_sel:[1,1,0] op_sel_hi:[1,0,1] neg_lo:[0,1,0]
    v_pk_mul_f32 v[234:235], v[226:227], v[242:243] op_sel:[0,0] op_sel_hi:[0,1]
    v_pk_mul_f32 v[236:237], v[228:229], v[250:251] op_sel:[0,0] op_sel_hi:[0,1]
    v_pk_mul_f32 v[238:239], v[230:231], v[244:245] op_sel:[0,0] op_sel_hi:[0,1]
    v_pk_mul_f32 v[240:241], v[232:233], v[244:245] op_sel:[0,0] op_sel_hi:[0,1]
    v_pk_fma_f32 v[226:227], v[226:227], v[242:243], v[234:235] op_sel:[1,1,0] op_sel_hi:[1,0,1] neg_lo:[0,1,0]
    v_pk_fma_f32 v[228:229], v[228:229], v[250:251], v[236:237] op_sel:[1,1,0] op_sel_hi:[1,0,1] neg_lo:[0,1,0]
    v_pk_fma_f32 v[230:231], v[230:231], v[244:245], v[238:239] op_sel:[1,1,0] op_sel_hi:[1,0,1] neg_lo:[0,1,0]
    v_pk_fma_f32 v[232:233], v[232:233], v[244:245], v[240:241] op_sel:[1,1,0] op_sel_hi:[1,0,1] neg_lo:[0,1,0]
    v_cvt_pk_bf16_f32 v222, v218, -v219
    ds_write_b32 v220, v222 offset:6864
    v_cvt_pk_bf16_f32 v222, v226, -v227
    v_cvt_pk_bf16_f32 v223, v228, -v229
    v_cvt_pk_bf16_f32 v224, v230, -v231
    v_cvt_pk_bf16_f32 v225, v232, -v233
    ds_write_b32 v220, v222 offset:1056
    ds_write_b32 v220, v223 offset:4752
    ds_write_b32 v220, v224 offset:7392
    ds_write_b32 v220, v225 offset:8976
    v_pk_mul_f32 v[234:235], v[226:227], v[242:243] op_sel:[0,0] op_sel_hi:[0,1]
    v_pk_mul_f32 v[236:237], v[228:229], v[250:251] op_sel:[0,0] op_sel_hi:[0,1]
    v_pk_mul_f32 v[238:239], v[230:231], v[252:253] op_sel:[0,0] op_sel_hi:[0,1]
    v_pk_mul_f32 v[240:241], v[232:233], v[244:245] op_sel:[0,0] op_sel_hi:[0,1]
    v_pk_fma_f32 v[226:227], v[226:227], v[242:243], v[234:235] op_sel:[1,1,0] op_sel_hi:[1,0,1] neg_lo:[0,1,0]
    v_pk_fma_f32 v[228:229], v[228:229], v[250:251], v[236:237] op_sel:[1,1,0] op_sel_hi:[1,0,1] neg_lo:[0,1,0]
    v_pk_fma_f32 v[230:231], v[230:231], v[252:253], v[238:239] op_sel:[1,1,0] op_sel_hi:[1,0,1] neg_lo:[0,1,0]
    v_pk_fma_f32 v[232:233], v[232:233], v[244:245], v[240:241] op_sel:[1,1,0] op_sel_hi:[1,0,1] neg_lo:[0,1,0]
    v_cvt_pk_bf16_f32 v222, v226, -v227
    v_cvt_pk_bf16_f32 v223, v228, -v229
    v_cvt_pk_bf16_f32 v224, v230, -v231
    v_cvt_pk_bf16_f32 v225, v232, -v233
    ds_write_b32 v220, v222 offset:1584
    ds_write_b32 v220, v223 offset:5280
    ds_write_b32 v220, v224 offset:7920
    ds_write_b32 v220, v225 offset:9504
    v_pk_mul_f32 v[234:235], v[226:227], v[242:243] op_sel:[0,0] op_sel_hi:[0,1]
    v_pk_mul_f32 v[236:237], v[228:229], v[250:251] op_sel:[0,0] op_sel_hi:[0,1]
    v_pk_mul_f32 v[240:241], v[232:233], v[244:245] op_sel:[0,0] op_sel_hi:[0,1]
    v_pk_fma_f32 v[226:227], v[226:227], v[242:243], v[234:235] op_sel:[1,1,0] op_sel_hi:[1,0,1] neg_lo:[0,1,0]
    v_pk_fma_f32 v[228:229], v[228:229], v[250:251], v[236:237] op_sel:[1,1,0] op_sel_hi:[1,0,1] neg_lo:[0,1,0]
    v_pk_fma_f32 v[232:233], v[232:233], v[244:245], v[240:241] op_sel:[1,1,0] op_sel_hi:[1,0,1] neg_lo:[0,1,0]
    v_cvt_pk_bf16_f32 v222, v226, -v227
    v_cvt_pk_bf16_f32 v223, v228, -v229
    v_cvt_pk_bf16_f32 v224, v232, -v233
    ds_write_b32 v220, v222 offset:2112
    ds_write_b32 v220, v223 offset:5808
    ds_write_b32 v220, v224 offset:10032
    v_pk_mul_f32 v[234:235], v[226:227], v[242:243] op_sel:[0,0] op_sel_hi:[0,1]
    v_pk_mul_f32 v[236:237], v[226:227], v[250:251] op_sel:[0,0] op_sel_hi:[0,1]
    v_pk_mul_f32 v[240:241], v[232:233], v[244:245] op_sel:[0,0] op_sel_hi:[0,1]
    v_pk_fma_f32 v[218:219], v[226:227], v[242:243], v[234:235] op_sel:[1,1,0] op_sel_hi:[1,0,1] neg_lo:[0,1,0]
    v_pk_fma_f32 v[228:229], v[226:227], v[250:251], v[236:237] op_sel:[1,1,0] op_sel_hi:[1,0,1] neg_lo:[0,1,0]
    v_pk_fma_f32 v[232:233], v[232:233], v[244:245], v[240:241] op_sel:[1,1,0] op_sel_hi:[1,0,1] neg_lo:[0,1,0]
    v_pk_mul_f32 v[234:235], v[218:219], v[250:251] op_sel:[0,0] op_sel_hi:[0,1]
    v_pk_fma_f32 v[226:227], v[218:219], v[250:251], v[234:235] op_sel:[1,1,0] op_sel_hi:[1,0,1] neg_lo:[0,1,0]
    v_cvt_pk_bf16_f32 v222, v218, -v219
    v_cvt_pk_bf16_f32 v223, v228, -v229
    v_cvt_pk_bf16_f32 v224, v232, -v233
    v_add_u32 v221, 2640, v220
    ds_write2_b32 v221, v222, v223 offset0:0 offset1:132
    ds_write_b32 v220, v224 offset:10560
    v_cvt_pk_bf16_f32 v222, v226, -v227
    ds_write_b32 v220, v222 offset:3696
    s_waitcnt vmcnt(0)
    v_lshrrev_b32 v2, 3, v0
    v_mul_u32_u24 v2, 132, v2
    v_and_b32 v3, 7, v0
    v_lshl_add_u32 v2, v3, 4, v2
    v_add_u32 v2, 154272, v2
    ds_write_b32 v2, v10 offset:0
    ds_write_b32 v2, v11 offset:4
    ds_write_b32 v2, v12 offset:8
    ds_write_b32 v2, v13 offset:12
    s_waitcnt lgkmcnt(0)
    s_barrier
    v_and_b32 v2, 7, v0
    v_mul_u32_u24 v2, 1056, v2
    v_lshrrev_b32 v3, 3, v0
    v_lshl_add_u32 v2, v3, 1, v2
    v_add_u32 v2, 154272, v2
    ds_read_u16_d16 v192, v2 offset:0
    ds_read_u16_d16_hi v193, v2 offset:132
    ds_read_u16_d16 v194, v2 offset:264
    ds_read_u16_d16_hi v195, v2 offset:396
    ds_read_u16_d16 v196, v2 offset:528
    ds_read_u16_d16_hi v197, v2 offset:660
    ds_read_u16_d16 v198, v2 offset:792
    ds_read_u16_d16_hi v199, v2 offset:924
    ds_read_b64_tr_b16 v[64:65], v24 offset:0
    ds_read_b64_tr_b16 v[66:67], v24 offset:512
    ds_read_b64_tr_b16 v[68:69], v24 offset:2048
    ds_read_b64_tr_b16 v[70:71], v24 offset:2560
    ds_read_b64_tr_b16 v[72:73], v24 offset:4096
    ds_read_b64_tr_b16 v[74:75], v24 offset:4608
    ds_read_b64_tr_b16 v[76:77], v24 offset:6144
    ds_read_b64_tr_b16 v[78:79], v24 offset:6656
    ds_read_b64_tr_b16 v[80:81], v24 offset:8192
    ds_read_b64_tr_b16 v[82:83], v24 offset:8704
    ds_read_b64_tr_b16 v[84:85], v24 offset:10240
    ds_read_b64_tr_b16 v[86:87], v24 offset:10752
    ds_read_b64_tr_b16 v[88:89], v24 offset:12288
    ds_read_b64_tr_b16 v[90:91], v24 offset:12800
    ds_read_b64_tr_b16 v[92:93], v24 offset:14336
    ds_read_b64_tr_b16 v[94:95], v24 offset:14848
    s_waitcnt lgkmcnt(14)
    v_mfma_f32_32x32x16_bf16 v[48:63], v[64:67], v[128:131], 0
    s_waitcnt lgkmcnt(12)
    v_mfma_f32_32x32x16_bf16 v[48:63], v[68:71], v[132:135], v[48:63]
    s_waitcnt lgkmcnt(10)
    v_mfma_f32_32x32x16_bf16 v[48:63], v[72:75], v[136:139], v[48:63]
    s_waitcnt lgkmcnt(8)
    v_mfma_f32_32x32x16_bf16 v[48:63], v[76:79], v[140:143], v[48:63]
    s_waitcnt lgkmcnt(6)
    v_mfma_f32_32x32x16_bf16 v[48:63], v[80:83], v[144:147], v[48:63]
    s_waitcnt lgkmcnt(4)
    v_mfma_f32_32x32x16_bf16 v[48:63], v[84:87], v[148:151], v[48:63]
    s_waitcnt lgkmcnt(2)
    v_mfma_f32_32x32x16_bf16 v[48:63], v[88:91], v[152:155], v[48:63]
    s_waitcnt lgkmcnt(0)
    v_mfma_f32_32x32x16_bf16 v[48:63], v[92:95], v[156:159], v[48:63]
    ds_read_b64_tr_b16 v[64:65], v24 offset:24576
    ds_read_b64_tr_b16 v[66:67], v24 offset:25088
    ds_read_b64_tr_b16 v[68:69], v24 offset:26624
    ds_read_b64_tr_b16 v[70:71], v24 offset:27136
    ds_read_b64_tr_b16 v[72:73], v24 offset:28672
    ds_read_b64_tr_b16 v[74:75], v24 offset:29184
    ds_read_b64_tr_b16 v[76:77], v24 offset:30720
    ds_read_b64_tr_b16 v[78:79], v24 offset:31232
    ds_read_b64_tr_b16 v[80:81], v24 offset:32768
    ds_read_b64_tr_b16 v[82:83], v24 offset:33280
    ds_read_b64_tr_b16 v[84:85], v24 offset:34816
    ds_read_b64_tr_b16 v[86:87], v24 offset:35328
    ds_read_b64_tr_b16 v[88:89], v24 offset:36864
    ds_read_b64_tr_b16 v[90:91], v24 offset:37376
    ds_read_b64_tr_b16 v[92:93], v24 offset:38912
    ds_read_b64_tr_b16 v[94:95], v24 offset:39424
    s_add_u32 s8, s4, s3
    s_and_b32 s8, s8, 7
    s_lshl_b32 s8, s8, 6
    v_lshrrev_b32 v3, 3, v0
    v_add_u32 v3, s8, v3
    v_lshlrev_b32 v3, 12, v3
    v_and_b32 v4, 7, v0
    v_lshl_add_u32 v3, v4, 4, v3
    s_lshl_b32 s8, s3, 7
    s_add_u32 s8, s8, 6291456
    v_or_b32 v10, v192, v193
    v_or_b32 v11, v194, v195
    v_or_b32 v12, v196, v197
    v_or_b32 v13, v198, v199
    buffer_store_dwordx4 v[10:13], v3, s[24:27], s8 offen sc1
    s_getpc_b64 s[56:57]
concat_heads__softmax_full_mha__ssm_conv_s4d__prompt_kernel_v_pc:
    s_add_u32 s56, s56, concat_heads__softmax_full_mha__ssm_conv_s4d__prompt_kernel_idx-concat_heads__softmax_full_mha__ssm_conv_s4d__prompt_kernel_v_pc
    s_addc_u32 s57, s57, 0
    v_and_b32 v2, 255, v0
    v_mul_u32_u24 v2, 24, v2
    global_load_dwordx2 v[212:213], v2, s[56:57]
    global_load_dwordx4 v[214:217], v2, s[56:57] offset:8
    s_waitcnt lgkmcnt(14)
    v_mfma_f32_32x32x16_bf16 v[48:63], v[64:67], v[160:163], v[48:63]
    s_waitcnt lgkmcnt(12)
    v_mfma_f32_32x32x16_bf16 v[48:63], v[68:71], v[164:167], v[48:63]
    s_waitcnt lgkmcnt(10)
    v_mfma_f32_32x32x16_bf16 v[48:63], v[72:75], v[168:171], v[48:63]
    s_waitcnt lgkmcnt(8)
    v_mfma_f32_32x32x16_bf16 v[48:63], v[76:79], v[172:175], v[48:63]
    s_waitcnt lgkmcnt(6)
    v_mfma_f32_32x32x16_bf16 v[48:63], v[80:83], v[176:179], v[48:63]
    s_waitcnt lgkmcnt(4)
    v_mfma_f32_32x32x16_bf16 v[48:63], v[84:87], v[180:183], v[48:63]
    s_waitcnt lgkmcnt(2)
    v_mfma_f32_32x32x16_bf16 v[48:63], v[88:91], v[184:187], v[48:63]
    s_waitcnt lgkmcnt(0)
    v_mfma_f32_32x32x16_bf16 v[48:63], v[92:95], v[188:191], v[48:63]
concat_heads__softmax_full_mha__ssm_conv_s4d__prompt_kernel_g1:
    v_lshlrev_b32 v2, 4, v1
    s_and_b32 s8, s5, 3
    s_lshl_b32 s8, s8, 11
    s_mul_i32 s9, s50, 49152
    s_add_u32 s8, s8, s9
    s_add_u32 s8, s8, 40960
    v_add_u32 v3, s8, v2
    s_cmp_eq_u32 s50, 1
    s_cbranch_scc1 concat_heads__softmax_full_mha__ssm_conv_s4d__prompt_kernel_qsv
    s_nop 2
    ds_write_b128 v3, v[56:59]
    ds_write_b128 v3, v[60:63] offset:1024
    v_mov_b32 v80, v48
    v_mov_b32 v81, v49
    v_mov_b32 v82, v50
    v_mov_b32 v83, v51
    v_mov_b32 v84, v52
    v_mov_b32 v85, v53
    v_mov_b32 v86, v54
    v_mov_b32 v87, v55
    s_branch concat_heads__softmax_full_mha__ssm_conv_s4d__prompt_kernel_qsj
concat_heads__softmax_full_mha__ssm_conv_s4d__prompt_kernel_qsv:
    s_nop 2
    ds_write_b128 v3, v[48:51]
    ds_write_b128 v3, v[52:55] offset:1024
    v_mov_b32 v80, v56
    v_mov_b32 v81, v57
    v_mov_b32 v82, v58
    v_mov_b32 v83, v59
    v_mov_b32 v84, v60
    v_mov_b32 v85, v61
    v_mov_b32 v86, v62
    v_mov_b32 v87, v63
concat_heads__softmax_full_mha__ssm_conv_s4d__prompt_kernel_qsj:
    s_waitcnt vmcnt(0) lgkmcnt(0)
    s_barrier
    s_cmp_lg_u32 s5, 0
    s_cbranch_scc1 concat_heads__softmax_full_mha__ssm_conv_s4d__prompt_kernel_fut
    s_lshl_b32 s8, s49, 6
    s_add_u32 s8, s8, 14696448
    v_and_b32 v198, 31, v1
    v_lshlrev_b32 v198, 6, v198
    buffer_load_dwordx2 v[196:197], v198, s[24:27], s8 offen sc1
    s_add_u32 s54, s4, s3
    s_and_b32 s54, s54, 7
    s_lshl_b32 s54, s54, 5
    s_add_u32 s54, s54, s3
    s_lshl_b32 s8, s54, 6
    s_add_u32 s8, s8, 14680064
    v_mov_b32 v2, s98
    v_mov_b32 v3, s99
    v_mov_b32 v4, 0
    s_mov_b64 s[10:11], exec
    s_mov_b64 exec, 1
    buffer_store_dwordx2 v[2:3], v4, s[24:27], s8 offen sc1
    s_mov_b64 exec, s[10:11]
concat_heads__softmax_full_mha__ssm_conv_s4d__prompt_kernel_fut:
    v_lshlrev_b32 v2, 4, v1
    s_and_b32 s8, s5, 3
    s_lshl_b32 s8, s8, 11
    s_xor_b32 s9, s50, 1
    s_mul_i32 s9, s9, 49152
    s_add_u32 s8, s8, s9
    s_add_u32 s8, s8, 40960
    v_add_u32 v4, s8, v2
    ds_read_b128 v[68:71], v4
    ds_read_b128 v[72:75], v4 offset:1024
    s_and_b32 s54, s5, 1
    s_bfe_u32 s56, s5, 0x10001
    s_lshr_b32 s57, s5, 2
    v_and_b32 v90, 15, v1
    v_mul_u32_u24 v90, 528, v90
    v_lshrrev_b32 v91, 4, v1
    v_lshl_add_u32 v90, v91, 4, v90
    s_mul_i32 s55, s54, 11088
    s_mul_i32 s58, s56, 8448
    s_add_u32 s58, s58, s55
    s_add_u32 s58, s58, 132096
    v_add_u32 v88, s58, v90
    s_mul_i32 s55, s54, 16896
    s_mul_i32 s58, s57, 8448
    s_add_u32 s58, s58, s55
    s_add_u32 s58, s58, 98304
    v_add_u32 v89, s58, v90
    ds_read_b128 v[92:95], v88 offset:0
    ds_read_b128 v[96:99], v89 offset:0
    ds_read_b128 v[100:103], v88 offset:64
    ds_read_b128 v[104:107], v89 offset:64
    ds_read_b128 v[108:111], v88 offset:128
    ds_read_b128 v[112:115], v89 offset:128
    ds_read_b128 v[116:119], v88 offset:192
    ds_read_b128 v[120:123], v89 offset:192
    s_waitcnt lgkmcnt(6)
    v_mfma_f32_16x16x32_bf16 v[124:127], v[92:95], v[96:99], 0
    ds_read_b128 v[92:95], v88 offset:256
    ds_read_b128 v[96:99], v89 offset:256
    s_waitcnt lgkmcnt(6)
    v_mfma_f32_16x16x32_bf16 v[124:127], v[100:103], v[104:107], v[124:127]
    ds_read_b128 v[100:103], v88 offset:320
    ds_read_b128 v[104:107], v89 offset:320
    s_waitcnt lgkmcnt(6)
    v_mfma_f32_16x16x32_bf16 v[124:127], v[108:111], v[112:115], v[124:127]
    ds_read_b128 v[108:111], v88 offset:384
    ds_read_b128 v[112:115], v89 offset:384
    s_waitcnt lgkmcnt(6)
    v_mfma_f32_16x16x32_bf16 v[124:127], v[116:119], v[120:123], v[124:127]
    ds_read_b128 v[116:119], v88 offset:448
    ds_read_b128 v[120:123], v89 offset:448
    s_waitcnt lgkmcnt(6)
    v_mfma_f32_16x16x32_bf16 v[124:127], v[92:95], v[96:99], v[124:127]
    s_waitcnt lgkmcnt(4)
    v_mfma_f32_16x16x32_bf16 v[124:127], v[100:103], v[104:107], v[124:127]
    s_waitcnt lgkmcnt(2)
    v_mfma_f32_16x16x32_bf16 v[124:127], v[108:111], v[112:115], v[124:127]
    s_waitcnt lgkmcnt(0)
    v_mfma_f32_16x16x32_bf16 v[124:127], v[116:119], v[120:123], v[124:127]
    s_or_b32 s58, s56, s57
    s_cmp_eq_u32 s58, 0
    s_cselect_b32 s58, 1, 0
    v_lshlrev_b32 v209, 16, v209
    v_cmp_gt_u32 vcc, s58, v1
    s_nop 1
    v_cndmask_b32 v209, 0, v209, vcc
    v_lshrrev_b32 v90, 4, v1
    v_lshlrev_b32 v90, 8, v90
    v_and_b32 v91, 15, v1
    v_lshl_add_u32 v90, v91, 1, v90
    s_mul_i32 s58, s54, 2112
    s_lshl_b32 s59, s56, 10
    s_add_u32 s58, s58, s59
    s_lshl_b32 s59, s57, 5
    s_add_u32 s58, s58, s59
    v_add_u32 v90, s58, v90
    v_add_f32 v124, v124, v209
    v_cvt_pk_bf16_f32 v92, v124, v124
    v_cvt_pk_bf16_f32 v93, v125, v125
    v_cvt_pk_bf16_f32 v94, v126, v126
    v_cvt_pk_bf16_f32 v95, v127, v127
    ds_write_b16 v90, v92 offset:16384
    ds_write_b16 v90, v93 offset:16448
    ds_write_b16 v90, v94 offset:16512
    ds_write_b16 v90, v95 offset:16576
    v_mov_b32 v91, 0
    v_mov_b32 v88, 0
    ds_write_b32 v88, v91 offset:18432
    ds_write_b32 v88, v91 offset:20544
    v_lshlrev_b32 v2, 4, v1
    s_and_b32 s6, s5, 3
    s_lshr_b32 s7, s5, 2
    v_lshlrev_b32 v10, 4, v1
    v_lshrrev_b32 v3, 5, v1
    v_lshlrev_b32 v3, 8, v3
    v_and_b32 v4, 15, v1
    v_lshl_add_u32 v11, v4, 4, v3
    v_add_u32 v11, 1024, v11
    s_mov_b32 s32, 0x0000ffff
    s_mov_b32 s33, 0x0000ffff
    s_lshl_b32 s8, s4, 2
    s_add_u32 s8, s8, s6
    s_lshl_b32 s8, s8, 1
    s_add_u32 s8, s8, s7
    s_lshl_b32 s10, s8, 16
    s_add_u32 s16, s68, s10
    s_addc_u32 s17, s69, 0
    s_and_b32 s17, s17, 0xffff
    s_mov_b32 s18, 0x10000
    s_mov_b32 s19, 0x20000
    s_lshl_b32 s30, s3, 11
    v_and_b32 v3, 27, v1
    v_mov_b32 v4, 0
    v_mov_b32 v5, 0x3f803f80
    v_cmp_eq_u32 vcc, 16, v3
    s_nop 1
    v_cndmask_b32 v4, v4, v5, vcc
    v_mov_b32 v36, v4
    v_mov_b32 v37, v4
    v_mov_b32 v38, v4
    v_mov_b32 v39, v4
    v_mov_b32 v40, v4
    v_mov_b32 v41, v4
    v_mov_b32 v42, v4
    v_mov_b32 v43, v4
    buffer_load_dwordx4 v[20:23], v10, s[16:19], s30 offen sc1
    s_mov_b64 exec, s[32:33]
    buffer_load_dwordx4 v[36:39], v11, s[16:19], s30 offen sc1
    buffer_load_dwordx4 v[40:43], v11, s[16:19], s30 offen offset:512 sc1
    s_mov_b64 exec, -1
    s_add_u32 s30, s30, 2048
    s_and_b32 s30, s30, 0xffff
    v_mov_b32 v44, v4
    v_mov_b32 v45, v4
    v_mov_b32 v46, v4
    v_mov_b32 v47, v4
    v_mov_b32 v48, v4
    v_mov_b32 v49, v4
    v_mov_b32 v50, v4
    v_mov_b32 v51, v4
    v_mov_b32 v52, v4
    v_mov_b32 v53, v4
    v_mov_b32 v54, v4
    v_mov_b32 v55, v4
    v_mov_b32 v56, v4
    v_mov_b32 v57, v4
    v_mov_b32 v58, v4
    v_mov_b32 v59, v4
    v_mov_b32 v60, v4
    v_mov_b32 v61, v4
    v_mov_b32 v62, v4
    v_mov_b32 v63, v4
    v_mov_b32 v64, v4
    v_mov_b32 v65, v4
    v_mov_b32 v66, v4
    v_mov_b32 v67, v4
    s_lshl_b32 s8, s52, 1
    s_add_u32 s8, s8, s50
    s_lshl_b32 s8, s8, 1
    s_add_u32 s8, s8, s51
    s_lshl_b32 s8, s8, 10
    s_add_u32 s8, s8, 155392
    v_add_u32 v4, s8, v2
    s_mov_b32 s9, 0x3eb8aa3b
    s_waitcnt lgkmcnt(0)
    v_add_f32 v68, v68, v80
    v_mul_f32 v68, s9, v68
    v_add_f32 v69, v69, v81
    v_mul_f32 v69, s9, v69
    v_add_f32 v70, v70, v82
    v_mul_f32 v70, s9, v70
    v_add_f32 v71, v71, v83
    v_mul_f32 v71, s9, v71
    v_add_f32 v72, v72, v84
    v_mul_f32 v72, s9, v72
    v_add_f32 v73, v73, v85
    v_mul_f32 v73, s9, v73
    v_add_f32 v74, v74, v86
    v_mul_f32 v74, s9, v74
    v_add_f32 v75, v75, v87
    v_mul_f32 v75, s9, v75
    v_cvt_pk_bf16_f32 v76, v68, v69
    v_cvt_pk_bf16_f32 v77, v70, v71
    v_cvt_pk_bf16_f32 v78, v72, v73
    v_cvt_pk_bf16_f32 v79, v74, v75
    ds_write_b128 v4, v[76:79]
    v_mov_b32 v3, 0
    v_dot2_f32_bf16 v3, v76, v76, v3
    v_dot2_f32_bf16 v3, v77, v77, v3
    v_dot2_f32_bf16 v3, v78, v78, v3
    v_dot2_f32_bf16 v3, v79, v79, v3
    s_nop 2
    v_mov_b32 v5, v3
    s_nop 1
    v_permlane32_swap_b32 v3, v5
    v_add_f32 v3, v3, v5
    v_mov_b32 v5, 0x41e00000
    v_cmp_nle_f32 vcc, v3, v5
    s_nop 0
    s_cmp_eq_u64 vcc, 0
    s_cbranch_scc1 concat_heads__softmax_full_mha__ssm_conv_s4d__prompt_kernel_nbq
    v_mov_b32 v3, 163612
    v_mov_b32 v5, 1
    ds_write_b32 v3, v5
concat_heads__softmax_full_mha__ssm_conv_s4d__prompt_kernel_nbq:
    s_cmp_lg_u32 s5, 0
    s_cbranch_scc1 concat_heads__softmax_full_mha__ssm_conv_s4d__prompt_kernel_pkv
    s_waitcnt vmcnt(4)
    s_or_b32 s56, s99, 1
    v_cmp_eq_u32 vcc, s98, v196
    v_or_b32 v2, 1, v197
    v_cmp_eq_u32 s[100:101], s56, v2
    s_nop 0
    s_and_b64 vcc, vcc, s[100:101]
    s_cmp_eq_u64 vcc, exec
    s_cbranch_scc0 concat_heads__softmax_full_mha__ssm_conv_s4d__prompt_kernel_pk1
    v_cmp_ne_u32 vcc, s99, v197
    s_nop 0
    s_cmp_lg_u64 vcc, 0
    s_cselect_b32 s9, 1, 0
    s_branch concat_heads__softmax_full_mha__ssm_conv_s4d__prompt_kernel_pk2
concat_heads__softmax_full_mha__ssm_conv_s4d__prompt_kernel_pk1:
    s_lshl_b32 s8, s49, 6
    s_add_u32 s8, s8, 14696448
    v_lshlrev_b32 v4, 6, v1
    s_mov_b64 s[10:11], exec
    s_mov_b64 exec, 0xffffffff
    s_mov_b32 s9, 0x40000
    s_or_b32 s56, s99, 1
concat_heads__softmax_full_mha__ssm_conv_s4d__prompt_kernel_plk:
    buffer_load_dwordx2 v[2:3], v4, s[24:27], s8 offen sc1
    s_waitcnt vmcnt(0)
    v_cmp_eq_u32 vcc, s98, v2
    v_or_b32 v2, 1, v3
    v_cmp_eq_u32 s[100:101], s56, v2
    s_sub_u32 s9, s9, 1
    s_cmp_eq_u32 s9, 0
    s_cbranch_scc1 concat_heads__softmax_full_mha__ssm_conv_s4d__prompt_kernel_plk_x
    s_and_b64 vcc, vcc, s[100:101]
    s_cmp_eq_u64 vcc, exec
    s_cbranch_scc0 concat_heads__softmax_full_mha__ssm_conv_s4d__prompt_kernel_plk
concat_heads__softmax_full_mha__ssm_conv_s4d__prompt_kernel_plk_x:
    v_cmp_ne_u32 vcc, s99, v3
    s_nop 0
    s_cmp_lg_u64 vcc, 0
    s_cselect_b32 s9, 1, 0
    s_mov_b64 exec, s[10:11]
concat_heads__softmax_full_mha__ssm_conv_s4d__prompt_kernel_pk2:
    v_mov_b32 v2, 163608
    v_mov_b32 v3, s9
    ds_write_b32 v2, v3
concat_heads__softmax_full_mha__ssm_conv_s4d__prompt_kernel_pkv:
    v_mov_b32 v148, 0
    v_mov_b32 v149, 0
    s_waitcnt lgkmcnt(0)
    s_barrier
    buffer_load_dwordx4 v[24:27], v10, s[16:19], s30 offen sc1
    s_mov_b64 exec, s[32:33]
    buffer_load_dwordx4 v[44:47], v11, s[16:19], s30 offen sc1
    buffer_load_dwordx4 v[48:51], v11, s[16:19], s30 offen offset:512 sc1
    s_mov_b64 exec, -1
    s_add_u32 s30, s30, 2048
    s_and_b32 s30, s30, 0xffff
    buffer_load_dwordx4 v[28:31], v10, s[16:19], s30 offen sc1
    s_mov_b64 exec, s[32:33]
    buffer_load_dwordx4 v[52:55], v11, s[16:19], s30 offen sc1
    buffer_load_dwordx4 v[56:59], v11, s[16:19], s30 offen offset:512 sc1
    s_mov_b64 exec, -1
    s_add_u32 s30, s30, 2048
    s_and_b32 s30, s30, 0xffff
    s_lshl_b32 s8, s6, 11
    s_add_u32 s8, s8, 155392
    s_lshl_b32 s9, s7, 10
    s_add_u32 s10, s8, s9
    s_xor_b32 s9, s9, 1024
    s_add_u32 s11, s8, s9
    v_add_u32 v2, s10, v10
    v_add_u32 v3, s11, v10
    v_mov_b32 v4, 163608
    ds_read_b128 v[12:15], v2
    ds_read_b128 v[16:19], v3
    ds_read_b64 v[4:5], v4
    s_waitcnt vmcnt(6) lgkmcnt(0)
    v_mfma_f32_32x32x16_bf16 v[68:83], v[20:23], v[12:15], 0
    v_or_b32 v4, v4, v5
    s_cmp_lt_u32 s5, 4
    v_readfirstlane_b32 s31, v4
    s_cbranch_scc1 concat_heads__softmax_full_mha__ssm_conv_s4d__prompt_kernel_np0
    s_setprio 1
concat_heads__softmax_full_mha__ssm_conv_s4d__prompt_kernel_np0:
    s_lshl_b32 s8, s49, 6
    s_add_u32 s8, s8, 14680064
    v_and_b32 v198, 31, v1
    v_lshlrev_b32 v198, 6, v198
    buffer_load_dwordx2 v[196:197], v198, s[24:27], s8 offen sc1
    s_nop 2
    v_exp_f32 v68, v68
    v_exp_f32 v69, v69
    v_exp_f32 v70, v70
    v_exp_f32 v71, v71
    v_cvt_pk_bf16_f32 v100, v68, v69
    v_mfma_f32_32x32x16_bf16 v[84:99], v[20:23], v[16:19], 0
    v_exp_f32 v72, v72
    s_lshr_b32 s54, s5, 2
    s_mul_i32 s55, s54, 138414144
    v_exp_f32 v73, v73
    v_cvt_pk_bf16_f32 v101, v70, v71
    v_exp_f32 v74, v74
    s_mul_i32 s56, s54, 16640
    s_add_u32 s56, s56, 98304
    v_exp_f32 v75, v75
    v_cvt_pk_bf16_f32 v102, v72, v73
    v_exp_f32 v76, v76
    s_nop 0
    v_add_u32 v212, s55, v212
    v_and_b32 v152, 0xffff, v212
    v_exp_f32 v77, v77
    v_cvt_pk_bf16_f32 v103, v74, v75
    v_exp_f32 v78, v78
    v_lshrrev_b32 v153, 16, v212
    v_add_u32 v213, s55, v213
    v_and_b32 v154, 0xffff, v213
    v_lshrrev_b32 v155, 16, v213
    v_add_u32 v214, s55, v214
    v_and_b32 v156, 0xffff, v214
    v_lshrrev_b32 v157, 16, v214
    v_add_u32 v215, s55, v215
    v_and_b32 v158, 0xffff, v215
    v_lshrrev_b32 v159, 16, v215
    v_add_u32 v216, s55, v216
    v_and_b32 v160, 0xffff, v216
    v_lshrrev_b32 v161, 16, v216
    v_add_u32 v217, s55, v217
    v_and_b32 v162, 0xffff, v217
    v_lshrrev_b32 v163, 16, v217
    ds_read_u16_d16 v152, v152 offset:16384
    ds_read_u16_d16_hi v153, v153 offset:16384
    ds_read_u16_d16 v154, v154 offset:16384
    ds_read_u16_d16_hi v155, v155 offset:16384
    ds_read_u16_d16 v156, v156 offset:16384
    ds_read_u16_d16_hi v157, v157 offset:16384
    ds_read_u16_d16 v158, v158 offset:16384
    ds_read_u16_d16_hi v159, v159 offset:16384
    ds_read_u16_d16 v160, v160 offset:16384
    ds_read_u16_d16_hi v161, v161 offset:16384
    ds_read_u16_d16 v162, v162 offset:16384
    ds_read_u16_d16_hi v163, v163 offset:16384
    v_and_b32 v176, 255, v0
    v_lshl_add_u32 v176, v176, 4, s56
    v_add_u32 v177, 4160, v176
    v_add_u32 v178, 8320, v176
    v_exp_f32 v79, v79
    v_cvt_pk_bf16_f32 v104, v76, v77
    v_exp_f32 v80, v80
    s_nop 0
    v_exp_f32 v81, v81
    v_cvt_pk_bf16_f32 v105, v78, v79
    v_exp_f32 v82, v82
    v_exp_f32 v83, v83
    v_cvt_pk_bf16_f32 v106, v80, v81
    v_cvt_pk_bf16_f32 v107, v82, v83
    v_exp_f32 v84, v84
    v_exp_f32 v85, v85
    s_waitcnt vmcnt(4)
    v_exp_f32 v86, v86
    v_exp_f32 v87, v87
    v_cvt_pk_bf16_f32 v108, v84, v85
    v_mfma_f32_32x32x16_bf16 v[68:83], v[24:27], v[12:15], 0
    v_exp_f32 v88, v88
    buffer_load_dwordx4 v[32:35], v10, s[16:19], s30 offen sc1
    v_exp_f32 v89, v89
    v_cvt_pk_bf16_f32 v109, v86, v87
    v_exp_f32 v90, v90
    s_mov_b64 exec, s[32:33]
    buffer_load_dwordx4 v[60:63], v11, s[16:19], s30 offen sc1
    buffer_load_dwordx4 v[64:67], v11, s[16:19], s30 offen offset:512 sc1
    s_mov_b64 exec, -1
    v_exp_f32 v91, v91
    v_cvt_pk_bf16_f32 v110, v88, v89
    v_exp_f32 v92, v92
    v_mfma_f32_32x32x16_bf16 v[116:131], v[36:39], v[100:103], 0
    s_add_u32 s30, s30, 2048
    s_and_b32 s30, s30, 0xffff
    v_exp_f32 v93, v93
    v_cvt_pk_bf16_f32 v111, v90, v91
    v_exp_f32 v94, v94
    s_waitcnt lgkmcnt(0)
    v_or_b32 v164, v152, v153
    v_or_b32 v165, v154, v155
    v_or_b32 v166, v156, v157
    v_or_b32 v167, v158, v159
    v_or_b32 v168, v160, v161
    v_or_b32 v169, v162, v163
    v_alignbit_b32 v170, v165, v164, 16
    v_alignbit_b32 v171, v166, v165, 16
    v_alignbit_b32 v172, v167, v166, 16
    v_alignbit_b32 v173, v168, v167, 16
    v_alignbit_b32 v174, v169, v168, 16
    ds_write_b128 v176, v[166:169]
    ds_write_b128 v176, v[170:173] offset:12480
    ds_write2_b32 v177, v171, v172 offset0:0 offset1:1
    ds_write2_b32 v177, v173, v174 offset0:2 offset1:3
    ds_write2_b32 v178, v165, v166 offset0:0 offset1:1
    ds_write2_b32 v178, v167, v168 offset0:2 offset1:3
    v_exp_f32 v95, v95
    v_cvt_pk_bf16_f32 v112, v92, v93
    v_exp_f32 v96, v96
    v_mfma_f32_32x32x16_bf16 v[116:131], v[40:43], v[104:107], v[116:131]
    v_exp_f32 v97, v97
    v_cvt_pk_bf16_f32 v113, v94, v95
    v_exp_f32 v98, v98
    v_exp_f32 v99, v99
    v_cvt_pk_bf16_f32 v114, v96, v97
    v_cvt_pk_bf16_f32 v115, v98, v99
    v_exp_f32 v68, v68
    v_exp_f32 v69, v69
    v_exp_f32 v70, v70
    v_exp_f32 v71, v71
    v_cvt_pk_bf16_f32 v100, v68, v69
    v_mfma_f32_32x32x16_bf16 v[84:99], v[24:27], v[16:19], 0
    v_exp_f32 v72, v72
    s_lshr_b32 s54, s5, 2
    s_and_b32 s55, s5, 3
    v_exp_f32 v73, v73
    v_cvt_pk_bf16_f32 v101, v70, v71
    v_exp_f32 v74, v74
    s_mul_i32 s56, s54, 16640
    s_lshl_b32 s57, s55, 9
    v_exp_f32 v75, v75
    v_cvt_pk_bf16_f32 v102, v72, v73
    v_exp_f32 v76, v76
    v_mfma_f32_32x32x16_bf16 v[132:147], v[36:39], v[108:111], 0
    s_sub_u32 s56, s56, s57
    s_add_u32 s56, s56, 100344
    v_exp_f32 v77, v77
    v_cvt_pk_bf16_f32 v103, v74, v75
    v_exp_f32 v78, v78
    v_and_b32 v202, 3, v1
    v_mul_u32_u24 v200, 4160, v202
    v_lshrrev_b32 v202, 5, v1
    v_lshl_add_u32 v200, v202, 4, v200
    v_bfe_u32 v202, v1, 2, 3
    v_lshlrev_b32 v202, 3, v202
    v_sub_u32 v200, v200, v202
    v_add_u32 v200, s56, v200
    s_mul_i32 s56, s54, 7680
    s_mul_i32 s57, s55, 640
    s_sub_u32 s56, s56, s57
    s_add_u32 s56, s56, 134144
    v_and_b32 v202, 31, v1
    v_mul_u32_u24 v201, 80, v202
    v_lshrrev_b32 v202, 5, v1
    v_lshl_add_u32 v201, v202, 4, v201
    v_add_u32 v201, s56, v201
    v_add_u32 v200, -192, v200
    v_add_u32 v201, -240, v201
    s_lshr_b32 s54, s5, 2
    s_mul_i32 s54, s54, 7680
    s_add_u32 s54, s54, 131584
    v_and_b32 v184, 255, v0
    v_lshl_add_u32 v185, v184, 4, s54
    v_mov_b32 v188, 0
    v_mov_b32 v189, 0
    v_mov_b32 v190, 0
    v_mov_b32 v191, 0
    v_cmp_gt_u32 vcc, 160, v184
    s_nop 0
    s_and_saveexec_b64 s[58:59], vcc
    ds_write_b128 v185, v[188:191]
    s_mov_b64 exec, s[58:59]
    v_exp_f32 v79, v79
    v_cvt_pk_bf16_f32 v104, v76, v77
    v_exp_f32 v80, v80
    v_mfma_f32_32x32x16_bf16 v[132:147], v[40:43], v[112:115], v[132:147]
    v_exp_f32 v81, v81
    v_cvt_pk_bf16_f32 v105, v78, v79
    v_exp_f32 v82, v82
    v_exp_f32 v83, v83
    v_cvt_pk_bf16_f32 v106, v80, v81
    v_cvt_pk_bf16_f32 v107, v82, v83
    v_exp_f32 v84, v84
    v_exp_f32 v85, v85
    s_waitcnt vmcnt(3)
    v_cmp_eq_u32 vcc, s98, v196
    v_cmp_eq_u32 s[100:101], s99, v197
    s_nop 0
    s_and_b64 vcc, vcc, s[100:101]
    s_cmp_eq_u64 vcc, exec
    s_cbranch_scc1 concat_heads__softmax_full_mha__ssm_conv_s4d__prompt_kernel_aux
    s_lshl_b32 s8, s49, 6
    s_add_u32 s8, s8, 14680064
    v_lshlrev_b32 v198, 6, v1
    s_mov_b64 s[10:11], exec
    s_mov_b64 exec, 0xffffffff
    s_mov_b32 s9, 0x40000
concat_heads__softmax_full_mha__ssm_conv_s4d__prompt_kernel_plu:
    buffer_load_dwordx2 v[196:197], v198, s[24:27], s8 offen sc1
    s_waitcnt vmcnt(0)
    v_cmp_eq_u32 vcc, s98, v196
    v_cmp_eq_u32 s[100:101], s99, v197
    s_sub_u32 s9, s9, 1
    s_cmp_eq_u32 s9, 0
    s_cbranch_scc1 concat_heads__softmax_full_mha__ssm_conv_s4d__prompt_kernel_plu_x
    s_and_b64 vcc, vcc, s[100:101]
    s_cmp_eq_u64 vcc, exec
    s_cbranch_scc0 concat_heads__softmax_full_mha__ssm_conv_s4d__prompt_kernel_plu
concat_heads__softmax_full_mha__ssm_conv_s4d__prompt_kernel_plu_x:
    s_mov_b64 exec, s[10:11]
concat_heads__softmax_full_mha__ssm_conv_s4d__prompt_kernel_aux:
    s_lshl_b32 s54, s4, 6
    s_lshl_b32 s55, s3, 1
    s_add_u32 s54, s54, s55
    s_lshl_b32 s54, s54, 12
    s_add_u32 s54, s54, 6291456
    v_lshlrev_b32 v198, 4, v0
    buffer_load_dwordx4 v[192:195], v198, s[24:27], s54 offen sc1
    v_exp_f32 v86, v86
    v_exp_f32 v87, v87
    v_cvt_pk_bf16_f32 v108, v84, v85
    v_mfma_f32_32x32x16_bf16 v[68:83], v[28:31], v[12:15], 0
    v_exp_f32 v88, v88
    buffer_load_dwordx4 v[20:23], v10, s[16:19], s30 offen sc1
    v_exp_f32 v89, v89
    v_cvt_pk_bf16_f32 v109, v86, v87
    v_exp_f32 v90, v90
    s_mov_b64 exec, s[32:33]
    buffer_load_dwordx4 v[36:39], v11, s[16:19], s30 offen sc1
    buffer_load_dwordx4 v[40:43], v11, s[16:19], s30 offen offset:512 sc1
    s_mov_b64 exec, -1
    v_exp_f32 v91, v91
    v_cvt_pk_bf16_f32 v110, v88, v89
    v_exp_f32 v92, v92
    v_mfma_f32_32x32x16_bf16 v[116:131], v[44:47], v[100:103], v[116:131]
    s_add_u32 s30, s30, 2048
    s_and_b32 s30, s30, 0xffff
    v_exp_f32 v93, v93
    v_cvt_pk_bf16_f32 v111, v90, v91
    v_exp_f32 v94, v94
    v_exp_f32 v95, v95
    v_cvt_pk_bf16_f32 v112, v92, v93
    v_exp_f32 v96, v96
    v_mfma_f32_32x32x16_bf16 v[116:131], v[48:51], v[104:107], v[116:131]
    v_exp_f32 v97, v97
    v_cvt_pk_bf16_f32 v113, v94, v95
    v_exp_f32 v98, v98
    v_exp_f32 v99, v99
    v_cvt_pk_bf16_f32 v114, v96, v97
    v_cvt_pk_bf16_f32 v115, v98, v99
    v_exp_f32 v68, v68
    v_exp_f32 v69, v69
    v_exp_f32 v70, v70
    v_exp_f32 v71, v71
    v_cvt_pk_bf16_f32 v100, v68, v69
    v_mfma_f32_32x32x16_bf16 v[84:99], v[28:31], v[16:19], 0
    v_exp_f32 v72, v72
    v_exp_f32 v73, v73
    v_cvt_pk_bf16_f32 v101, v70, v71
    v_exp_f32 v74, v74
    v_exp_f32 v75, v75
    v_cvt_pk_bf16_f32 v102, v72, v73
    v_exp_f32 v76, v76
    v_mfma_f32_32x32x16_bf16 v[132:147], v[44:47], v[108:111], v[132:147]
    v_exp_f32 v77, v77
    v_cvt_pk_bf16_f32 v103, v74, v75
    v_exp_f32 v78, v78
    s_cmp_lg_u32 s5, 7
    s_cbranch_scc1 .Lzt_p0
    v_and_b32 v164, 3, v0
    v_bfe_u32 v165, v0, 2, 3
    v_mul_u32_u24 v165, 4160, v165
    v_lshl_add_u32 v164, v164, 4, v165
    v_add_u32 v164, 102400, v164
    v_mov_b32 v170, 0
    v_mov_b32 v171, 0
    v_mov_b32 v172, 0
    v_mov_b32 v173, 0
    s_mov_b64 s[58:59], exec
    s_mov_b64 exec, 0xffffffff
    ds_write_b128 v164, v[170:173]
    s_mov_b64 exec, s[58:59]
.Lzt_p0:
    v_mov_b64 v[152:153], 0
    v_mov_b64 v[154:155], 0
    v_mov_b64 v[156:157], 0
    v_mov_b64 v[158:159], 0
    v_mov_b64 v[160:161], 0
    v_mov_b64 v[162:163], 0
    v_mov_b64 v[164:165], 0
    v_mov_b64 v[166:167], 0
    v_exp_f32 v79, v79
    v_cvt_pk_bf16_f32 v104, v76, v77
    v_exp_f32 v80, v80
    v_mfma_f32_32x32x16_bf16 v[132:147], v[48:51], v[112:115], v[132:147]
    v_exp_f32 v81, v81
    v_cvt_pk_bf16_f32 v105, v78, v79
    v_exp_f32 v82, v82
    v_exp_f32 v83, v83
    v_cvt_pk_bf16_f32 v106, v80, v81
    v_cvt_pk_bf16_f32 v107, v82, v83
    v_exp_f32 v84, v84
    v_exp_f32 v85, v85
    s_waitcnt vmcnt(4)
    v_exp_f32 v86, v86
    v_exp_f32 v87, v87
    v_cvt_pk_bf16_f32 v108, v84, v85
    v_mfma_f32_32x32x16_bf16 v[68:83], v[32:35], v[12:15], 0
    v_exp_f32 v88, v88
    buffer_load_dwordx4 v[24:27], v10, s[16:19], s30 offen sc1
    s_setprio 0
    v_exp_f32 v89, v89
    v_cvt_pk_bf16_f32 v109, v86, v87
    v_exp_f32 v90, v90
    s_mov_b64 exec, s[32:33]
    buffer_load_dwordx4 v[44:47], v11, s[16:19], s30 offen sc1
    buffer_load_dwordx4 v[48:51], v11, s[16:19], s30 offen offset:512 sc1
    s_mov_b64 exec, -1
    v_exp_f32 v91, v91
    v_cvt_pk_bf16_f32 v110, v88, v89
    v_exp_f32 v92, v92
    v_mfma_f32_32x32x16_bf16 v[116:131], v[52:55], v[100:103], v[116:131]
    s_add_u32 s30, s30, 2048
    s_and_b32 s30, s30, 0xffff
    v_exp_f32 v93, v93
    v_cvt_pk_bf16_f32 v111, v90, v91
    v_exp_f32 v94, v94
    v_exp_f32 v95, v95
    v_cvt_pk_bf16_f32 v112, v92, v93
    v_exp_f32 v96, v96
    v_mfma_f32_32x32x16_bf16 v[116:131], v[56:59], v[104:107], v[116:131]
    v_exp_f32 v97, v97
    v_cvt_pk_bf16_f32 v113, v94, v95
    v_exp_f32 v98, v98
    v_exp_f32 v99, v99
    v_cvt_pk_bf16_f32 v114, v96, v97
    v_cvt_pk_bf16_f32 v115, v98, v99
    v_exp_f32 v68, v68
    v_exp_f32 v69, v69
    v_exp_f32 v70, v70
    v_exp_f32 v71, v71
    v_cvt_pk_bf16_f32 v100, v68, v69
    v_mfma_f32_32x32x16_bf16 v[84:99], v[32:35], v[16:19], 0
    v_exp_f32 v72, v72
    v_mov_b64 v[168:169], 0
    v_mov_b64 v[170:171], 0
    v_exp_f32 v73, v73
    v_cvt_pk_bf16_f32 v101, v70, v71
    v_exp_f32 v74, v74
    v_mov_b64 v[172:173], 0
    v_mov_b64 v[174:175], 0
    v_exp_f32 v75, v75
    v_cvt_pk_bf16_f32 v102, v72, v73
    v_exp_f32 v76, v76
    v_mfma_f32_32x32x16_bf16 v[132:147], v[52:55], v[108:111], v[132:147]
    v_mov_b64 v[176:177], 0
    v_mov_b64 v[178:179], 0
    v_exp_f32 v77, v77
    v_cvt_pk_bf16_f32 v103, v74, v75
    v_exp_f32 v78, v78
    v_mov_b64 v[180:181], 0
    v_mov_b64 v[182:183], 0
    v_exp_f32 v79, v79
    v_cvt_pk_bf16_f32 v104, v76, v77
    v_exp_f32 v80, v80
    v_mfma_f32_32x32x16_bf16 v[132:147], v[56:59], v[112:115], v[132:147]
    v_exp_f32 v81, v81
    v_cvt_pk_bf16_f32 v105, v78, v79
    v_exp_f32 v82, v82
    v_exp_f32 v83, v83
    v_cvt_pk_bf16_f32 v106, v80, v81
    v_cvt_pk_bf16_f32 v107, v82, v83
    v_exp_f32 v84, v84
    v_exp_f32 v85, v85
    s_waitcnt vmcnt(3)
    v_exp_f32 v86, v86
    v_exp_f32 v87, v87
    v_cvt_pk_bf16_f32 v108, v84, v85
    v_mfma_f32_32x32x16_bf16 v[68:83], v[20:23], v[12:15], 0
    v_exp_f32 v88, v88
    buffer_load_dwordx4 v[28:31], v10, s[16:19], s30 offen sc1
    s_lshr_b32 s54, s5, 2
    s_mul_i32 s54, s54, 7680
    v_exp_f32 v89, v89
    v_cvt_pk_bf16_f32 v109, v86, v87
    v_exp_f32 v90, v90
    s_mov_b64 exec, s[32:33]
    buffer_load_dwordx4 v[52:55], v11, s[16:19], s30 offen sc1
    buffer_load_dwordx4 v[56:59], v11, s[16:19], s30 offen offset:512 sc1
    s_mov_b64 exec, -1
    s_add_u32 s54, s54, 134144
    v_bfe_u32 v198, v0, 2, 6
    v_mul_u32_u24 v198, 80, v198
    v_and_b32 v199, 3, v0
    v_lshl_add_u32 v198, v199, 4, v198
    v_add_u32 v198, s54, v198
    ds_write_b128 v198, v[192:195]
    v_exp_f32 v91, v91
    v_cvt_pk_bf16_f32 v110, v88, v89
    v_exp_f32 v92, v92
    v_mfma_f32_32x32x16_bf16 v[116:131], v[60:63], v[100:103], v[116:131]
    s_add_u32 s30, s30, 2048
    s_and_b32 s30, s30, 0xffff
    v_exp_f32 v93, v93
    v_cvt_pk_bf16_f32 v111, v90, v91
    v_exp_f32 v94, v94
    v_exp_f32 v95, v95
    v_cvt_pk_bf16_f32 v112, v92, v93
    v_exp_f32 v96, v96
    v_mfma_f32_32x32x16_bf16 v[116:131], v[64:67], v[104:107], v[116:131]
    v_exp_f32 v97, v97
    v_cvt_pk_bf16_f32 v113, v94, v95
    v_exp_f32 v98, v98
    v_exp_f32 v99, v99
    v_cvt_pk_bf16_f32 v114, v96, v97
    v_cvt_pk_bf16_f32 v115, v98, v99
    s_waitcnt lgkmcnt(0)
    s_barrier
    ds_read_b64 v[184:185], v200 offset:2240
    ds_read_b64 v[186:187], v200 offset:2248
    ds_read_b128 v[196:199], v201 offset:2800
    ds_read_b64 v[188:189], v200 offset:192
    ds_read_b64 v[190:191], v200 offset:200
    ds_read_b128 v[192:195], v201 offset:240
    s_cmp_lt_u32 s5, 4
    s_cbranch_scc1 concat_heads__softmax_full_mha__ssm_conv_s4d__prompt_kernel_np
    s_setprio 1
concat_heads__softmax_full_mha__ssm_conv_s4d__prompt_kernel_np:
    s_mov_b32 s34, 0
.p2align 6
concat_heads__softmax_full_mha__ssm_conv_s4d__prompt_kernel_loop:
    v_exp_f32 v68, v68
    s_waitcnt lgkmcnt(0)
    v_mfma_f32_32x32x16_bf16 v[152:167], v[184:187], v[192:195], v[152:167]
    v_exp_f32 v69, v69
    v_exp_f32 v70, v70
    v_exp_f32 v71, v71
    v_cvt_pk_bf16_f32 v100, v68, v69
    v_mfma_f32_32x32x16_bf16 v[84:99], v[20:23], v[16:19], 0
    v_exp_f32 v72, v72
    v_exp_f32 v73, v73
    v_cvt_pk_bf16_f32 v101, v70, v71
    v_exp_f32 v74, v74
    v_exp_f32 v75, v75
    v_cvt_pk_bf16_f32 v102, v72, v73
    v_exp_f32 v76, v76
    v_mfma_f32_32x32x16_bf16 v[132:147], v[60:63], v[108:111], v[132:147]
    v_exp_f32 v77, v77
    v_cvt_pk_bf16_f32 v103, v74, v75
    v_exp_f32 v78, v78
    v_exp_f32 v79, v79
    v_cvt_pk_bf16_f32 v104, v76, v77
    v_exp_f32 v80, v80
    v_mfma_f32_32x32x16_bf16 v[132:147], v[64:67], v[112:115], v[132:147]
    v_exp_f32 v81, v81
    v_cvt_pk_bf16_f32 v105, v78, v79
    v_exp_f32 v82, v82
    v_exp_f32 v83, v83
    v_cvt_pk_bf16_f32 v106, v80, v81
    v_cvt_pk_bf16_f32 v107, v82, v83
    v_exp_f32 v84, v84
    v_mfma_f32_32x32x16_bf16 v[168:183], v[184:187], v[196:199], v[168:183]
    v_exp_f32 v85, v85
    s_waitcnt vmcnt(3)
    v_exp_f32 v86, v86
    v_exp_f32 v87, v87
    v_cvt_pk_bf16_f32 v108, v84, v85
    v_mfma_f32_32x32x16_bf16 v[68:83], v[24:27], v[12:15], 0
    v_exp_f32 v88, v88
    buffer_load_dwordx4 v[32:35], v10, s[16:19], s30 offen sc1
    ds_read_b64 v[184:185], v200 offset:2272
    ds_read_b64 v[186:187], v200 offset:2280
    v_exp_f32 v89, v89
    v_cvt_pk_bf16_f32 v109, v86, v87
    v_exp_f32 v90, v90
    s_mov_b64 exec, s[32:33]
    buffer_load_dwordx4 v[60:63], v11, s[16:19], s30 offen sc1
    buffer_load_dwordx4 v[64:67], v11, s[16:19], s30 offen offset:512 sc1
    s_mov_b64 exec, -1
    ds_read_b128 v[196:199], v201 offset:2832
    v_exp_f32 v91, v91
    v_cvt_pk_bf16_f32 v110, v88, v89
    v_exp_f32 v92, v92
    v_mfma_f32_32x32x16_bf16 v[116:131], v[36:39], v[100:103], v[116:131]
    s_add_u32 s30, s30, 2048
    s_and_b32 s30, s30, 0xffff
    v_exp_f32 v93, v93
    v_cvt_pk_bf16_f32 v111, v90, v91
    v_exp_f32 v94, v94
    v_exp_f32 v95, v95
    v_cvt_pk_bf16_f32 v112, v92, v93
    v_exp_f32 v96, v96
    v_mfma_f32_32x32x16_bf16 v[116:131], v[40:43], v[104:107], v[116:131]
    v_exp_f32 v97, v97
    v_cvt_pk_bf16_f32 v113, v94, v95
    v_exp_f32 v98, v98
    v_exp_f32 v99, v99
    v_cvt_pk_bf16_f32 v114, v96, v97
    v_cvt_pk_bf16_f32 v115, v98, v99
    v_exp_f32 v68, v68
    v_mfma_f32_32x32x16_bf16 v[168:183], v[188:191], v[192:195], v[168:183]
    v_exp_f32 v69, v69
    v_exp_f32 v70, v70
    v_exp_f32 v71, v71
    v_cvt_pk_bf16_f32 v100, v68, v69
    v_mfma_f32_32x32x16_bf16 v[84:99], v[24:27], v[16:19], 0
    v_exp_f32 v72, v72
    ds_read_b64 v[188:189], v200 offset:224
    ds_read_b64 v[190:191], v200 offset:232
    v_exp_f32 v73, v73
    v_cvt_pk_bf16_f32 v101, v70, v71
    v_exp_f32 v74, v74
    ds_read_b128 v[192:195], v201 offset:272
    v_exp_f32 v75, v75
    v_cvt_pk_bf16_f32 v102, v72, v73
    v_exp_f32 v76, v76
    v_mfma_f32_32x32x16_bf16 v[132:147], v[36:39], v[108:111], v[132:147]
    v_exp_f32 v77, v77
    v_cvt_pk_bf16_f32 v103, v74, v75
    v_exp_f32 v78, v78
    v_exp_f32 v79, v79
    v_cvt_pk_bf16_f32 v104, v76, v77
    v_exp_f32 v80, v80
    v_mfma_f32_32x32x16_bf16 v[132:147], v[40:43], v[112:115], v[132:147]
    v_exp_f32 v81, v81
    v_cvt_pk_bf16_f32 v105, v78, v79
    v_exp_f32 v82, v82
    v_exp_f32 v83, v83
    v_cvt_pk_bf16_f32 v106, v80, v81
    v_cvt_pk_bf16_f32 v107, v82, v83
    v_exp_f32 v84, v84
    s_waitcnt lgkmcnt(0)
    v_mfma_f32_32x32x16_bf16 v[152:167], v[184:187], v[192:195], v[152:167]
    v_exp_f32 v85, v85
    s_waitcnt vmcnt(3)
    v_exp_f32 v86, v86
    v_exp_f32 v87, v87
    v_cvt_pk_bf16_f32 v108, v84, v85
    v_mfma_f32_32x32x16_bf16 v[68:83], v[28:31], v[12:15], 0
    v_exp_f32 v88, v88
    buffer_load_dwordx4 v[20:23], v10, s[16:19], s30 offen sc1
    v_exp_f32 v89, v89
    v_cvt_pk_bf16_f32 v109, v86, v87
    v_exp_f32 v90, v90
    s_mov_b64 exec, s[32:33]
    buffer_load_dwordx4 v[36:39], v11, s[16:19], s30 offen sc1
    buffer_load_dwordx4 v[40:43], v11, s[16:19], s30 offen offset:512 sc1
    s_mov_b64 exec, -1
    v_exp_f32 v91, v91
    v_cvt_pk_bf16_f32 v110, v88, v89
    v_exp_f32 v92, v92
    v_mfma_f32_32x32x16_bf16 v[116:131], v[44:47], v[100:103], v[116:131]
    s_add_u32 s30, s30, 2048
    s_and_b32 s30, s30, 0xffff
    v_exp_f32 v93, v93
    v_cvt_pk_bf16_f32 v111, v90, v91
    v_exp_f32 v94, v94
    v_exp_f32 v95, v95
    v_cvt_pk_bf16_f32 v112, v92, v93
    v_exp_f32 v96, v96
    v_mfma_f32_32x32x16_bf16 v[116:131], v[48:51], v[104:107], v[116:131]
    v_exp_f32 v97, v97
    v_cvt_pk_bf16_f32 v113, v94, v95
    v_exp_f32 v98, v98
    v_exp_f32 v99, v99
    v_cvt_pk_bf16_f32 v114, v96, v97
    v_cvt_pk_bf16_f32 v115, v98, v99
    v_exp_f32 v68, v68
    v_mfma_f32_32x32x16_bf16 v[168:183], v[184:187], v[196:199], v[168:183]
    v_exp_f32 v69, v69
    v_exp_f32 v70, v70
    v_exp_f32 v71, v71
    v_cvt_pk_bf16_f32 v100, v68, v69
    v_mfma_f32_32x32x16_bf16 v[84:99], v[28:31], v[16:19], 0
    v_exp_f32 v72, v72
    ds_read_b64 v[184:185], v200 offset:2176
    ds_read_b64 v[186:187], v200 offset:2184
    v_exp_f32 v73, v73
    v_cvt_pk_bf16_f32 v101, v70, v71
    v_exp_f32 v74, v74
    ds_read_b128 v[196:199], v201 offset:2720
    v_exp_f32 v75, v75
    v_cvt_pk_bf16_f32 v102, v72, v73
    v_exp_f32 v76, v76
    v_mfma_f32_32x32x16_bf16 v[132:147], v[44:47], v[108:111], v[132:147]
    v_exp_f32 v77, v77
    v_cvt_pk_bf16_f32 v103, v74, v75
    v_exp_f32 v78, v78
    v_exp_f32 v79, v79
    v_cvt_pk_bf16_f32 v104, v76, v77
    v_exp_f32 v80, v80
    v_mfma_f32_32x32x16_bf16 v[132:147], v[48:51], v[112:115], v[132:147]
    v_exp_f32 v81, v81
    v_cvt_pk_bf16_f32 v105, v78, v79
    v_exp_f32 v82, v82
    v_exp_f32 v83, v83
    v_cvt_pk_bf16_f32 v106, v80, v81
    v_cvt_pk_bf16_f32 v107, v82, v83
    v_exp_f32 v84, v84
    v_mfma_f32_32x32x16_bf16 v[168:183], v[188:191], v[192:195], v[168:183]
    v_exp_f32 v85, v85
    s_waitcnt vmcnt(3)
    v_exp_f32 v86, v86
    v_exp_f32 v87, v87
    v_cvt_pk_bf16_f32 v108, v84, v85
    v_mfma_f32_32x32x16_bf16 v[68:83], v[32:35], v[12:15], 0
    v_exp_f32 v88, v88
    buffer_load_dwordx4 v[24:27], v10, s[16:19], s30 offen sc1
    ds_read_b64 v[188:189], v200 offset:128
    ds_read_b64 v[190:191], v200 offset:136
    v_exp_f32 v89, v89
    v_cvt_pk_bf16_f32 v109, v86, v87
    v_exp_f32 v90, v90
    s_mov_b64 exec, s[32:33]
    buffer_load_dwordx4 v[44:47], v11, s[16:19], s30 offen sc1
    buffer_load_dwordx4 v[48:51], v11, s[16:19], s30 offen offset:512 sc1
    s_mov_b64 exec, -1
    ds_read_b128 v[192:195], v201 offset:160
    v_exp_f32 v91, v91
    v_cvt_pk_bf16_f32 v110, v88, v89
    v_exp_f32 v92, v92
    v_mfma_f32_32x32x16_bf16 v[116:131], v[52:55], v[100:103], v[116:131]
    s_add_u32 s30, s30, 2048
    s_and_b32 s30, s30, 0xffff
    v_exp_f32 v93, v93
    v_cvt_pk_bf16_f32 v111, v90, v91
    v_exp_f32 v94, v94
    v_exp_f32 v95, v95
    v_cvt_pk_bf16_f32 v112, v92, v93
    v_exp_f32 v96, v96
    v_mfma_f32_32x32x16_bf16 v[116:131], v[56:59], v[104:107], v[116:131]
    v_exp_f32 v97, v97
    v_cvt_pk_bf16_f32 v113, v94, v95
    v_exp_f32 v98, v98
    v_exp_f32 v99, v99
    v_cvt_pk_bf16_f32 v114, v96, v97
    v_cvt_pk_bf16_f32 v115, v98, v99
    v_exp_f32 v68, v68
    s_waitcnt lgkmcnt(0)
    v_mfma_f32_32x32x16_bf16 v[152:167], v[184:187], v[192:195], v[152:167]
    v_exp_f32 v69, v69
    v_exp_f32 v70, v70
    v_exp_f32 v71, v71
    v_cvt_pk_bf16_f32 v100, v68, v69
    v_mfma_f32_32x32x16_bf16 v[84:99], v[32:35], v[16:19], 0
    v_exp_f32 v72, v72
    v_exp_f32 v73, v73
    v_cvt_pk_bf16_f32 v101, v70, v71
    v_exp_f32 v74, v74
    v_exp_f32 v75, v75
    v_cvt_pk_bf16_f32 v102, v72, v73
    v_exp_f32 v76, v76
    v_mfma_f32_32x32x16_bf16 v[132:147], v[52:55], v[108:111], v[132:147]
    v_exp_f32 v77, v77
    v_cvt_pk_bf16_f32 v103, v74, v75
    v_exp_f32 v78, v78
    v_exp_f32 v79, v79
    v_cvt_pk_bf16_f32 v104, v76, v77
    v_exp_f32 v80, v80
    v_mfma_f32_32x32x16_bf16 v[132:147], v[56:59], v[112:115], v[132:147]
    v_exp_f32 v81, v81
    v_cvt_pk_bf16_f32 v105, v78, v79
    v_exp_f32 v82, v82
    v_exp_f32 v83, v83
    v_cvt_pk_bf16_f32 v106, v80, v81
    v_cvt_pk_bf16_f32 v107, v82, v83
    v_exp_f32 v84, v84
    v_mfma_f32_32x32x16_bf16 v[168:183], v[184:187], v[196:199], v[168:183]
    v_exp_f32 v85, v85
    s_waitcnt vmcnt(3)
    v_exp_f32 v86, v86
    v_exp_f32 v87, v87
    v_cvt_pk_bf16_f32 v108, v84, v85
    v_mfma_f32_32x32x16_bf16 v[68:83], v[20:23], v[12:15], 0
    v_exp_f32 v88, v88
    buffer_load_dwordx4 v[28:31], v10, s[16:19], s30 offen sc1
    ds_read_b64 v[184:185], v200 offset:2208
    ds_read_b64 v[186:187], v200 offset:2216
    v_exp_f32 v89, v89
    v_cvt_pk_bf16_f32 v109, v86, v87
    v_exp_f32 v90, v90
    s_mov_b64 exec, s[32:33]
    buffer_load_dwordx4 v[52:55], v11, s[16:19], s30 offen sc1
    buffer_load_dwordx4 v[56:59], v11, s[16:19], s30 offen offset:512 sc1
    s_mov_b64 exec, -1
    ds_read_b128 v[196:199], v201 offset:2752
    v_exp_f32 v91, v91
    v_cvt_pk_bf16_f32 v110, v88, v89
    v_exp_f32 v92, v92
    v_mfma_f32_32x32x16_bf16 v[116:131], v[60:63], v[100:103], v[116:131]
    s_add_u32 s30, s30, 2048
    s_and_b32 s30, s30, 0xffff
    v_exp_f32 v93, v93
    v_cvt_pk_bf16_f32 v111, v90, v91
    v_exp_f32 v94, v94
    v_exp_f32 v95, v95
    v_cvt_pk_bf16_f32 v112, v92, v93
    v_exp_f32 v96, v96
    v_mfma_f32_32x32x16_bf16 v[116:131], v[64:67], v[104:107], v[116:131]
    v_exp_f32 v97, v97
    v_cvt_pk_bf16_f32 v113, v94, v95
    v_exp_f32 v98, v98
    v_exp_f32 v99, v99
    v_cvt_pk_bf16_f32 v114, v96, v97
    v_cvt_pk_bf16_f32 v115, v98, v99
    s_add_u32 s34, s34, 1
    s_cmp_eq_u32 s34, 6
    s_cbranch_scc0 concat_heads__softmax_full_mha__ssm_conv_s4d__prompt_kernel_kp0
    s_setprio 0
concat_heads__softmax_full_mha__ssm_conv_s4d__prompt_kernel_kp0:
    v_exp_f32 v68, v68
    v_mfma_f32_32x32x16_bf16 v[168:183], v[188:191], v[192:195], v[168:183]
    v_exp_f32 v69, v69
    v_exp_f32 v70, v70
    v_exp_f32 v71, v71
    v_cvt_pk_bf16_f32 v100, v68, v69
    v_mfma_f32_32x32x16_bf16 v[84:99], v[20:23], v[16:19], 0
    v_exp_f32 v72, v72
    ds_read_b64 v[188:189], v200 offset:160
    ds_read_b64 v[190:191], v200 offset:168
    v_exp_f32 v73, v73
    v_cvt_pk_bf16_f32 v101, v70, v71
    v_exp_f32 v74, v74
    ds_read_b128 v[192:195], v201 offset:192
    v_exp_f32 v75, v75
    v_cvt_pk_bf16_f32 v102, v72, v73
    v_exp_f32 v76, v76
    v_mfma_f32_32x32x16_bf16 v[132:147], v[60:63], v[108:111], v[132:147]
    v_exp_f32 v77, v77
    v_cvt_pk_bf16_f32 v103, v74, v75
    v_exp_f32 v78, v78
    v_exp_f32 v79, v79
    v_cvt_pk_bf16_f32 v104, v76, v77
    v_exp_f32 v80, v80
    v_mfma_f32_32x32x16_bf16 v[132:147], v[64:67], v[112:115], v[132:147]
    v_exp_f32 v81, v81
    v_cvt_pk_bf16_f32 v105, v78, v79
    v_exp_f32 v82, v82
    v_exp_f32 v83, v83
    v_cvt_pk_bf16_f32 v106, v80, v81
    v_cvt_pk_bf16_f32 v107, v82, v83
    v_exp_f32 v84, v84
    s_waitcnt lgkmcnt(0)
    v_mfma_f32_32x32x16_bf16 v[152:167], v[184:187], v[192:195], v[152:167]
    v_exp_f32 v85, v85
    s_waitcnt vmcnt(3)
    v_exp_f32 v86, v86
    v_exp_f32 v87, v87
    v_cvt_pk_bf16_f32 v108, v84, v85
    v_mfma_f32_32x32x16_bf16 v[68:83], v[24:27], v[12:15], 0
    v_exp_f32 v88, v88
    buffer_load_dwordx4 v[32:35], v10, s[16:19], s30 offen sc1
    v_exp_f32 v89, v89
    v_cvt_pk_bf16_f32 v109, v86, v87
    v_exp_f32 v90, v90
    s_mov_b64 exec, s[32:33]
    buffer_load_dwordx4 v[60:63], v11, s[16:19], s30 offen sc1
    buffer_load_dwordx4 v[64:67], v11, s[16:19], s30 offen offset:512 sc1
    s_mov_b64 exec, -1
    v_exp_f32 v91, v91
    v_cvt_pk_bf16_f32 v110, v88, v89
    v_exp_f32 v92, v92
    v_mfma_f32_32x32x16_bf16 v[116:131], v[36:39], v[100:103], v[116:131]
    s_add_u32 s30, s30, 2048
    s_and_b32 s30, s30, 0xffff
    v_exp_f32 v93, v93
    v_cvt_pk_bf16_f32 v111, v90, v91
    v_exp_f32 v94, v94
    v_exp_f32 v95, v95
    v_cvt_pk_bf16_f32 v112, v92, v93
    v_exp_f32 v96, v96
    v_mfma_f32_32x32x16_bf16 v[116:131], v[40:43], v[104:107], v[116:131]
    v_exp_f32 v97, v97
    v_cvt_pk_bf16_f32 v113, v94, v95
    v_exp_f32 v98, v98
    v_exp_f32 v99, v99
    v_cvt_pk_bf16_f32 v114, v96, v97
    v_cvt_pk_bf16_f32 v115, v98, v99
    v_exp_f32 v68, v68
    v_mfma_f32_32x32x16_bf16 v[168:183], v[184:187], v[196:199], v[168:183]
    v_exp_f32 v69, v69
    v_exp_f32 v70, v70
    v_exp_f32 v71, v71
    v_cvt_pk_bf16_f32 v100, v68, v69
    v_mfma_f32_32x32x16_bf16 v[84:99], v[24:27], v[16:19], 0
    v_exp_f32 v72, v72
    ds_read_b64 v[184:185], v200 offset:2112
    ds_read_b64 v[186:187], v200 offset:2120
    v_exp_f32 v73, v73
    v_cvt_pk_bf16_f32 v101, v70, v71
    v_exp_f32 v74, v74
    ds_read_b128 v[196:199], v201 offset:2640
    v_exp_f32 v75, v75
    v_cvt_pk_bf16_f32 v102, v72, v73
    v_exp_f32 v76, v76
    v_mfma_f32_32x32x16_bf16 v[132:147], v[36:39], v[108:111], v[132:147]
    v_exp_f32 v77, v77
    v_cvt_pk_bf16_f32 v103, v74, v75
    v_exp_f32 v78, v78
    v_exp_f32 v79, v79
    v_cvt_pk_bf16_f32 v104, v76, v77
    v_exp_f32 v80, v80
    v_mfma_f32_32x32x16_bf16 v[132:147], v[40:43], v[112:115], v[132:147]
    v_exp_f32 v81, v81
    v_cvt_pk_bf16_f32 v105, v78, v79
    v_exp_f32 v82, v82
    v_exp_f32 v83, v83
    v_cvt_pk_bf16_f32 v106, v80, v81
    v_cvt_pk_bf16_f32 v107, v82, v83
    v_exp_f32 v84, v84
    v_mfma_f32_32x32x16_bf16 v[168:183], v[188:191], v[192:195], v[168:183]
    v_exp_f32 v85, v85
    s_waitcnt vmcnt(3)
    v_exp_f32 v86, v86
    v_exp_f32 v87, v87
    v_cvt_pk_bf16_f32 v108, v84, v85
    v_mfma_f32_32x32x16_bf16 v[68:83], v[28:31], v[12:15], 0
    v_exp_f32 v88, v88
    buffer_load_dwordx4 v[20:23], v10, s[16:19], s30 offen sc1
    ds_read_b64 v[188:189], v200 offset:64
    ds_read_b64 v[190:191], v200 offset:72
    v_exp_f32 v89, v89
    v_cvt_pk_bf16_f32 v109, v86, v87
    v_exp_f32 v90, v90
    s_mov_b64 exec, s[32:33]
    buffer_load_dwordx4 v[36:39], v11, s[16:19], s30 offen sc1
    buffer_load_dwordx4 v[40:43], v11, s[16:19], s30 offen offset:512 sc1
    s_mov_b64 exec, -1
    ds_read_b128 v[192:195], v201 offset:80
    v_exp_f32 v91, v91
    v_cvt_pk_bf16_f32 v110, v88, v89
    v_exp_f32 v92, v92
    v_mfma_f32_32x32x16_bf16 v[116:131], v[44:47], v[100:103], v[116:131]
    s_add_u32 s30, s30, 2048
    s_and_b32 s30, s30, 0xffff
    v_exp_f32 v93, v93
    v_cvt_pk_bf16_f32 v111, v90, v91
    v_exp_f32 v94, v94
    v_exp_f32 v95, v95
    v_cvt_pk_bf16_f32 v112, v92, v93
    v_exp_f32 v96, v96
    v_mfma_f32_32x32x16_bf16 v[116:131], v[48:51], v[104:107], v[116:131]
    v_exp_f32 v97, v97
    v_cvt_pk_bf16_f32 v113, v94, v95
    v_exp_f32 v98, v98
    v_exp_f32 v99, v99
    v_cvt_pk_bf16_f32 v114, v96, v97
    v_cvt_pk_bf16_f32 v115, v98, v99
    v_exp_f32 v68, v68
    s_waitcnt lgkmcnt(0)
    v_mfma_f32_32x32x16_bf16 v[152:167], v[184:187], v[192:195], v[152:167]
    v_exp_f32 v69, v69
    v_exp_f32 v70, v70
    v_exp_f32 v71, v71
    v_cvt_pk_bf16_f32 v100, v68, v69
    v_mfma_f32_32x32x16_bf16 v[84:99], v[28:31], v[16:19], 0
    v_exp_f32 v72, v72
    v_exp_f32 v73, v73
    v_cvt_pk_bf16_f32 v101, v70, v71
    v_exp_f32 v74, v74
    v_exp_f32 v75, v75
    v_cvt_pk_bf16_f32 v102, v72, v73
    v_exp_f32 v76, v76
    v_mfma_f32_32x32x16_bf16 v[132:147], v[44:47], v[108:111], v[132:147]
    v_exp_f32 v77, v77
    v_cvt_pk_bf16_f32 v103, v74, v75
    v_exp_f32 v78, v78
    v_exp_f32 v79, v79
    v_cvt_pk_bf16_f32 v104, v76, v77
    v_exp_f32 v80, v80
    v_mfma_f32_32x32x16_bf16 v[132:147], v[48:51], v[112:115], v[132:147]
    v_exp_f32 v81, v81
    v_cvt_pk_bf16_f32 v105, v78, v79
    v_exp_f32 v82, v82
    v_exp_f32 v83, v83
    v_cvt_pk_bf16_f32 v106, v80, v81
    v_cvt_pk_bf16_f32 v107, v82, v83
    v_exp_f32 v84, v84
    v_mfma_f32_32x32x16_bf16 v[168:183], v[184:187], v[196:199], v[168:183]
    v_exp_f32 v85, v85
    s_waitcnt vmcnt(3)
    v_exp_f32 v86, v86
    v_exp_f32 v87, v87
    v_cvt_pk_bf16_f32 v108, v84, v85
    v_mfma_f32_32x32x16_bf16 v[68:83], v[32:35], v[12:15], 0
    v_exp_f32 v88, v88
    buffer_load_dwordx4 v[24:27], v10, s[16:19], s30 offen sc1
    ds_read_b64 v[184:185], v200 offset:2144
    ds_read_b64 v[186:187], v200 offset:2152
    v_exp_f32 v89, v89
    v_cvt_pk_bf16_f32 v109, v86, v87
    v_exp_f32 v90, v90
    s_mov_b64 exec, s[32:33]
    buffer_load_dwordx4 v[44:47], v11, s[16:19], s30 offen sc1
    buffer_load_dwordx4 v[48:51], v11, s[16:19], s30 offen offset:512 sc1
    s_mov_b64 exec, -1
    ds_read_b128 v[196:199], v201 offset:2672
    v_exp_f32 v91, v91
    v_cvt_pk_bf16_f32 v110, v88, v89
    v_exp_f32 v92, v92
    v_mfma_f32_32x32x16_bf16 v[116:131], v[52:55], v[100:103], v[116:131]
    s_add_u32 s30, s30, 2048
    s_and_b32 s30, s30, 0xffff
    v_exp_f32 v93, v93
    v_cvt_pk_bf16_f32 v111, v90, v91
    v_exp_f32 v94, v94
    v_exp_f32 v95, v95
    v_cvt_pk_bf16_f32 v112, v92, v93
    v_exp_f32 v96, v96
    v_mfma_f32_32x32x16_bf16 v[116:131], v[56:59], v[104:107], v[116:131]
    v_exp_f32 v97, v97
    v_cvt_pk_bf16_f32 v113, v94, v95
    v_exp_f32 v98, v98
    v_exp_f32 v99, v99
    v_cvt_pk_bf16_f32 v114, v96, v97
    v_cvt_pk_bf16_f32 v115, v98, v99
    v_exp_f32 v68, v68
    v_mfma_f32_32x32x16_bf16 v[168:183], v[188:191], v[192:195], v[168:183]
    v_exp_f32 v69, v69
    v_exp_f32 v70, v70
    v_exp_f32 v71, v71
    v_cvt_pk_bf16_f32 v100, v68, v69
    v_mfma_f32_32x32x16_bf16 v[84:99], v[32:35], v[16:19], 0
    v_exp_f32 v72, v72
    ds_read_b64 v[188:189], v200 offset:96
    ds_read_b64 v[190:191], v200 offset:104
    v_exp_f32 v73, v73
    v_cvt_pk_bf16_f32 v101, v70, v71
    v_exp_f32 v74, v74
    ds_read_b128 v[192:195], v201 offset:112
    v_exp_f32 v75, v75
    v_cvt_pk_bf16_f32 v102, v72, v73
    v_exp_f32 v76, v76
    v_mfma_f32_32x32x16_bf16 v[132:147], v[52:55], v[108:111], v[132:147]
    v_exp_f32 v77, v77
    v_cvt_pk_bf16_f32 v103, v74, v75
    v_exp_f32 v78, v78
    v_exp_f32 v79, v79
    v_cvt_pk_bf16_f32 v104, v76, v77
    v_exp_f32 v80, v80
    v_mfma_f32_32x32x16_bf16 v[132:147], v[56:59], v[112:115], v[132:147]
    v_exp_f32 v81, v81
    v_cvt_pk_bf16_f32 v105, v78, v79
    v_exp_f32 v82, v82
    v_exp_f32 v83, v83
    v_cvt_pk_bf16_f32 v106, v80, v81
    v_cvt_pk_bf16_f32 v107, v82, v83
    v_exp_f32 v84, v84
    s_waitcnt lgkmcnt(0)
    v_mfma_f32_32x32x16_bf16 v[152:167], v[184:187], v[192:195], v[152:167]
    v_exp_f32 v85, v85
    s_waitcnt vmcnt(3)
    v_exp_f32 v86, v86
    v_exp_f32 v87, v87
    v_cvt_pk_bf16_f32 v108, v84, v85
    v_mfma_f32_32x32x16_bf16 v[68:83], v[20:23], v[12:15], 0
    v_exp_f32 v88, v88
    buffer_load_dwordx4 v[28:31], v10, s[16:19], s30 offen sc1
    v_exp_f32 v89, v89
    v_cvt_pk_bf16_f32 v109, v86, v87
    v_exp_f32 v90, v90
    s_mov_b64 exec, s[32:33]
    buffer_load_dwordx4 v[52:55], v11, s[16:19], s30 offen sc1
    buffer_load_dwordx4 v[56:59], v11, s[16:19], s30 offen offset:512 sc1
    s_mov_b64 exec, -1
    v_exp_f32 v91, v91
    v_cvt_pk_bf16_f32 v110, v88, v89
    v_exp_f32 v92, v92
    v_mfma_f32_32x32x16_bf16 v[116:131], v[60:63], v[100:103], v[116:131]
    s_add_u32 s30, s30, 2048
    s_and_b32 s30, s30, 0xffff
    v_exp_f32 v93, v93
    v_cvt_pk_bf16_f32 v111, v90, v91
    v_exp_f32 v94, v94
    v_exp_f32 v95, v95
    v_cvt_pk_bf16_f32 v112, v92, v93
    v_exp_f32 v96, v96
    v_mfma_f32_32x32x16_bf16 v[116:131], v[64:67], v[104:107], v[116:131]
    v_exp_f32 v97, v97
    v_cvt_pk_bf16_f32 v113, v94, v95
    v_exp_f32 v98, v98
    v_exp_f32 v99, v99
    v_cvt_pk_bf16_f32 v114, v96, v97
    v_cvt_pk_bf16_f32 v115, v98, v99
    s_add_u32 s34, s34, 1
    s_cmp_eq_u32 s34, 6
    s_cbranch_scc0 concat_heads__softmax_full_mha__ssm_conv_s4d__prompt_kernel_kp1
    s_setprio 0
concat_heads__softmax_full_mha__ssm_conv_s4d__prompt_kernel_kp1:
    v_exp_f32 v68, v68
    v_mfma_f32_32x32x16_bf16 v[168:183], v[184:187], v[196:199], v[168:183]
    v_exp_f32 v69, v69
    v_exp_f32 v70, v70
    v_exp_f32 v71, v71
    v_cvt_pk_bf16_f32 v100, v68, v69
    v_mfma_f32_32x32x16_bf16 v[84:99], v[20:23], v[16:19], 0
    v_exp_f32 v72, v72
    ds_read_b64 v[184:185], v200 offset:2048
    ds_read_b64 v[186:187], v200 offset:2056
    v_exp_f32 v73, v73
    v_cvt_pk_bf16_f32 v101, v70, v71
    v_exp_f32 v74, v74
    ds_read_b128 v[196:199], v201 offset:2560
    v_exp_f32 v75, v75
    v_cvt_pk_bf16_f32 v102, v72, v73
    v_exp_f32 v76, v76
    v_mfma_f32_32x32x16_bf16 v[132:147], v[60:63], v[108:111], v[132:147]
    v_exp_f32 v77, v77
    v_cvt_pk_bf16_f32 v103, v74, v75
    v_exp_f32 v78, v78
    v_exp_f32 v79, v79
    v_cvt_pk_bf16_f32 v104, v76, v77
    v_exp_f32 v80, v80
    v_mfma_f32_32x32x16_bf16 v[132:147], v[64:67], v[112:115], v[132:147]
    v_exp_f32 v81, v81
    v_cvt_pk_bf16_f32 v105, v78, v79
    v_exp_f32 v82, v82
    v_exp_f32 v83, v83
    v_cvt_pk_bf16_f32 v106, v80, v81
    v_cvt_pk_bf16_f32 v107, v82, v83
    v_exp_f32 v84, v84
    v_mfma_f32_32x32x16_bf16 v[168:183], v[188:191], v[192:195], v[168:183]
    v_exp_f32 v85, v85
    s_waitcnt vmcnt(3)
    v_exp_f32 v86, v86
    v_exp_f32 v87, v87
    v_cvt_pk_bf16_f32 v108, v84, v85
    v_mfma_f32_32x32x16_bf16 v[68:83], v[24:27], v[12:15], 0
    v_exp_f32 v88, v88
    buffer_load_dwordx4 v[32:35], v10, s[16:19], s30 offen sc1
    ds_read_b64 v[188:189], v200 offset:0
    ds_read_b64 v[190:191], v200 offset:8
    v_exp_f32 v89, v89
    v_cvt_pk_bf16_f32 v109, v86, v87
    v_exp_f32 v90, v90
    s_mov_b64 exec, s[32:33]
    buffer_load_dwordx4 v[60:63], v11, s[16:19], s30 offen sc1
    buffer_load_dwordx4 v[64:67], v11, s[16:19], s30 offen offset:512 sc1
    s_mov_b64 exec, -1
    ds_read_b128 v[192:195], v201 offset:0
    v_exp_f32 v91, v91
    v_cvt_pk_bf16_f32 v110, v88, v89
    v_exp_f32 v92, v92
    v_mfma_f32_32x32x16_bf16 v[116:131], v[36:39], v[100:103], v[116:131]
    s_add_u32 s30, s30, 2048
    s_and_b32 s30, s30, 0xffff
    v_exp_f32 v93, v93
    v_cvt_pk_bf16_f32 v111, v90, v91
    v_exp_f32 v94, v94
    v_exp_f32 v95, v95
    v_cvt_pk_bf16_f32 v112, v92, v93
    v_exp_f32 v96, v96
    v_mfma_f32_32x32x16_bf16 v[116:131], v[40:43], v[104:107], v[116:131]
    v_exp_f32 v97, v97
    v_cvt_pk_bf16_f32 v113, v94, v95
    v_exp_f32 v98, v98
    v_exp_f32 v99, v99
    v_cvt_pk_bf16_f32 v114, v96, v97
    v_cvt_pk_bf16_f32 v115, v98, v99
    v_exp_f32 v68, v68
    s_waitcnt lgkmcnt(0)
    v_mfma_f32_32x32x16_bf16 v[152:167], v[184:187], v[192:195], v[152:167]
    v_exp_f32 v69, v69
    v_exp_f32 v70, v70
    v_exp_f32 v71, v71
    v_cvt_pk_bf16_f32 v100, v68, v69
    v_mfma_f32_32x32x16_bf16 v[84:99], v[24:27], v[16:19], 0
    v_exp_f32 v72, v72
    v_exp_f32 v73, v73
    v_cvt_pk_bf16_f32 v101, v70, v71
    v_exp_f32 v74, v74
    v_exp_f32 v75, v75
    v_cvt_pk_bf16_f32 v102, v72, v73
    v_exp_f32 v76, v76
    v_mfma_f32_32x32x16_bf16 v[132:147], v[36:39], v[108:111], v[132:147]
    v_exp_f32 v77, v77
    v_cvt_pk_bf16_f32 v103, v74, v75
    v_exp_f32 v78, v78
    v_exp_f32 v79, v79
    v_cvt_pk_bf16_f32 v104, v76, v77
    v_exp_f32 v80, v80
    v_mfma_f32_32x32x16_bf16 v[132:147], v[40:43], v[112:115], v[132:147]
    v_exp_f32 v81, v81
    v_cvt_pk_bf16_f32 v105, v78, v79
    v_exp_f32 v82, v82
    v_exp_f32 v83, v83
    v_cvt_pk_bf16_f32 v106, v80, v81
    v_cvt_pk_bf16_f32 v107, v82, v83
    v_exp_f32 v84, v84
    v_mfma_f32_32x32x16_bf16 v[168:183], v[184:187], v[196:199], v[168:183]
    v_exp_f32 v85, v85
    s_waitcnt vmcnt(3)
    v_exp_f32 v86, v86
    v_exp_f32 v87, v87
    v_cvt_pk_bf16_f32 v108, v84, v85
    v_mfma_f32_32x32x16_bf16 v[68:83], v[28:31], v[12:15], 0
    v_exp_f32 v88, v88
    buffer_load_dwordx4 v[20:23], v10, s[16:19], s30 offen sc1
    ds_read_b64 v[184:185], v200 offset:2080
    ds_read_b64 v[186:187], v200 offset:2088
    v_exp_f32 v89, v89
    v_cvt_pk_bf16_f32 v109, v86, v87
    v_exp_f32 v90, v90
    s_mov_b64 exec, s[32:33]
    buffer_load_dwordx4 v[36:39], v11, s[16:19], s30 offen sc1
    buffer_load_dwordx4 v[40:43], v11, s[16:19], s30 offen offset:512 sc1
    s_mov_b64 exec, -1
    ds_read_b128 v[196:199], v201 offset:2592
    v_exp_f32 v91, v91
    v_cvt_pk_bf16_f32 v110, v88, v89
    v_exp_f32 v92, v92
    v_mfma_f32_32x32x16_bf16 v[116:131], v[44:47], v[100:103], v[116:131]
    s_add_u32 s30, s30, 2048
    s_and_b32 s30, s30, 0xffff
    v_exp_f32 v93, v93
    v_cvt_pk_bf16_f32 v111, v90, v91
    v_exp_f32 v94, v94
    v_exp_f32 v95, v95
    v_cvt_pk_bf16_f32 v112, v92, v93
    v_exp_f32 v96, v96
    v_mfma_f32_32x32x16_bf16 v[116:131], v[48:51], v[104:107], v[116:131]
    v_exp_f32 v97, v97
    v_cvt_pk_bf16_f32 v113, v94, v95
    v_exp_f32 v98, v98
    v_exp_f32 v99, v99
    v_cvt_pk_bf16_f32 v114, v96, v97
    v_cvt_pk_bf16_f32 v115, v98, v99
    v_exp_f32 v68, v68
    v_mfma_f32_32x32x16_bf16 v[168:183], v[188:191], v[192:195], v[168:183]
    v_exp_f32 v69, v69
    v_exp_f32 v70, v70
    v_exp_f32 v71, v71
    v_cvt_pk_bf16_f32 v100, v68, v69
    v_mfma_f32_32x32x16_bf16 v[84:99], v[28:31], v[16:19], 0
    v_exp_f32 v72, v72
    ds_read_b64 v[188:189], v200 offset:32
    ds_read_b64 v[190:191], v200 offset:40
    v_exp_f32 v73, v73
    v_cvt_pk_bf16_f32 v101, v70, v71
    v_exp_f32 v74, v74
    ds_read_b128 v[192:195], v201 offset:32
    v_exp_f32 v75, v75
    v_cvt_pk_bf16_f32 v102, v72, v73
    v_exp_f32 v76, v76
    v_mfma_f32_32x32x16_bf16 v[132:147], v[44:47], v[108:111], v[132:147]
    v_exp_f32 v77, v77
    v_cvt_pk_bf16_f32 v103, v74, v75
    v_exp_f32 v78, v78
    v_exp_f32 v79, v79
    v_cvt_pk_bf16_f32 v104, v76, v77
    v_exp_f32 v80, v80
    v_mfma_f32_32x32x16_bf16 v[132:147], v[48:51], v[112:115], v[132:147]
    v_exp_f32 v81, v81
    v_cvt_pk_bf16_f32 v105, v78, v79
    v_exp_f32 v82, v82
    v_exp_f32 v83, v83
    v_cvt_pk_bf16_f32 v106, v80, v81
    v_cvt_pk_bf16_f32 v107, v82, v83
    v_exp_f32 v84, v84
    s_waitcnt lgkmcnt(0)
    v_mfma_f32_32x32x16_bf16 v[152:167], v[184:187], v[192:195], v[152:167]
    v_exp_f32 v85, v85
    s_waitcnt vmcnt(3)
    v_exp_f32 v86, v86
    v_exp_f32 v87, v87
    v_cvt_pk_bf16_f32 v108, v84, v85
    v_mfma_f32_32x32x16_bf16 v[68:83], v[32:35], v[12:15], 0
    v_exp_f32 v88, v88
    buffer_load_dwordx4 v[24:27], v10, s[16:19], s30 offen sc1
    v_exp_f32 v89, v89
    v_cvt_pk_bf16_f32 v109, v86, v87
    v_exp_f32 v90, v90
    s_mov_b64 exec, s[32:33]
    buffer_load_dwordx4 v[44:47], v11, s[16:19], s30 offen sc1
    buffer_load_dwordx4 v[48:51], v11, s[16:19], s30 offen offset:512 sc1
    s_mov_b64 exec, -1
    v_exp_f32 v91, v91
    v_cvt_pk_bf16_f32 v110, v88, v89
    v_exp_f32 v92, v92
    v_mfma_f32_32x32x16_bf16 v[116:131], v[52:55], v[100:103], v[116:131]
    s_add_u32 s30, s30, 2048
    s_and_b32 s30, s30, 0xffff
    v_exp_f32 v93, v93
    v_cvt_pk_bf16_f32 v111, v90, v91
    v_exp_f32 v94, v94
    v_exp_f32 v95, v95
    v_cvt_pk_bf16_f32 v112, v92, v93
    v_exp_f32 v96, v96
    v_mfma_f32_32x32x16_bf16 v[116:131], v[56:59], v[104:107], v[116:131]
    v_exp_f32 v97, v97
    v_cvt_pk_bf16_f32 v113, v94, v95
    v_exp_f32 v98, v98
    v_exp_f32 v99, v99
    v_cvt_pk_bf16_f32 v114, v96, v97
    v_cvt_pk_bf16_f32 v115, v98, v99
    v_exp_f32 v68, v68
    v_mfma_f32_32x32x16_bf16 v[168:183], v[184:187], v[196:199], v[168:183]
    v_exp_f32 v69, v69
    v_exp_f32 v70, v70
    v_exp_f32 v71, v71
    v_cvt_pk_bf16_f32 v100, v68, v69
    v_mfma_f32_32x32x16_bf16 v[84:99], v[32:35], v[16:19], 0
    v_exp_f32 v72, v72
    v_add_u32 v200, -256, v200
    v_add_u32 v201, -320, v201
    v_exp_f32 v73, v73
    v_cvt_pk_bf16_f32 v101, v70, v71
    v_exp_f32 v74, v74
    ds_read_b64 v[184:185], v200 offset:2240
    ds_read_b64 v[186:187], v200 offset:2248
    ds_read_b128 v[196:199], v201 offset:2800
    v_exp_f32 v75, v75
    v_cvt_pk_bf16_f32 v102, v72, v73
    v_exp_f32 v76, v76
    v_mfma_f32_32x32x16_bf16 v[132:147], v[52:55], v[108:111], v[132:147]
    v_exp_f32 v77, v77
    v_cvt_pk_bf16_f32 v103, v74, v75
    v_exp_f32 v78, v78
    v_exp_f32 v79, v79
    v_cvt_pk_bf16_f32 v104, v76, v77
    v_exp_f32 v80, v80
    v_mfma_f32_32x32x16_bf16 v[132:147], v[56:59], v[112:115], v[132:147]
    v_exp_f32 v81, v81
    v_cvt_pk_bf16_f32 v105, v78, v79
    v_exp_f32 v82, v82
    v_exp_f32 v83, v83
    v_cvt_pk_bf16_f32 v106, v80, v81
    v_cvt_pk_bf16_f32 v107, v82, v83
    v_exp_f32 v84, v84
    v_mfma_f32_32x32x16_bf16 v[168:183], v[188:191], v[192:195], v[168:183]
    v_exp_f32 v85, v85
    s_waitcnt vmcnt(3)
    v_exp_f32 v86, v86
    v_exp_f32 v87, v87
    v_cvt_pk_bf16_f32 v108, v84, v85
    v_mfma_f32_32x32x16_bf16 v[68:83], v[20:23], v[12:15], 0
    v_exp_f32 v88, v88
    buffer_load_dwordx4 v[28:31], v10, s[16:19], s30 offen sc1
    ds_read_b64 v[188:189], v200 offset:192
    ds_read_b64 v[190:191], v200 offset:200
    v_exp_f32 v89, v89
    v_cvt_pk_bf16_f32 v109, v86, v87
    v_exp_f32 v90, v90
    s_mov_b64 exec, s[32:33]
    buffer_load_dwordx4 v[52:55], v11, s[16:19], s30 offen sc1
    buffer_load_dwordx4 v[56:59], v11, s[16:19], s30 offen offset:512 sc1
    s_mov_b64 exec, -1
    ds_read_b128 v[192:195], v201 offset:240
    v_exp_f32 v91, v91
    v_cvt_pk_bf16_f32 v110, v88, v89
    v_exp_f32 v92, v92
    v_mfma_f32_32x32x16_bf16 v[116:131], v[60:63], v[100:103], v[116:131]
    s_add_u32 s30, s30, 2048
    s_and_b32 s30, s30, 0xffff
    v_exp_f32 v93, v93
    v_cvt_pk_bf16_f32 v111, v90, v91
    v_exp_f32 v94, v94
    v_exp_f32 v95, v95
    v_cvt_pk_bf16_f32 v112, v92, v93
    v_exp_f32 v96, v96
    v_mfma_f32_32x32x16_bf16 v[116:131], v[64:67], v[104:107], v[116:131]
    v_exp_f32 v97, v97
    v_cvt_pk_bf16_f32 v113, v94, v95
    v_exp_f32 v98, v98
    v_exp_f32 v99, v99
    v_cvt_pk_bf16_f32 v114, v96, v97
    v_cvt_pk_bf16_f32 v115, v98, v99
    s_add_u32 s34, s34, 1
    s_cmp_eq_u32 s34, 6
    s_cbranch_scc0 concat_heads__softmax_full_mha__ssm_conv_s4d__prompt_kernel_kp2
    s_setprio 0
concat_heads__softmax_full_mha__ssm_conv_s4d__prompt_kernel_kp2:
    s_cmp_lt_u32 s34, 6
    s_cbranch_scc1 concat_heads__softmax_full_mha__ssm_conv_s4d__prompt_kernel_loop
    v_exp_f32 v68, v68
    v_exp_f32 v69, v69
    v_exp_f32 v70, v70
    v_exp_f32 v71, v71
    v_cvt_pk_bf16_f32 v100, v68, v69
    v_mfma_f32_32x32x16_bf16 v[84:99], v[20:23], v[16:19], 0
    v_exp_f32 v72, v72
    s_waitcnt lgkmcnt(0)
    s_lshr_b32 s54, s5, 2
    v_exp_f32 v73, v73
    v_cvt_pk_bf16_f32 v101, v70, v71
    v_exp_f32 v74, v74
    s_and_b32 s55, s5, 3
    s_lshl_b32 s56, s54, 15
    v_exp_f32 v75, v75
    v_cvt_pk_bf16_f32 v102, v72, v73
    v_exp_f32 v76, v76
    v_mfma_f32_32x32x16_bf16 v[132:147], v[60:63], v[108:111], v[132:147]
    s_lshl_b32 s57, s55, 11
    s_add_u32 s57, s57, s56
    v_exp_f32 v77, v77
    v_cvt_pk_bf16_f32 v103, v74, v75
    v_exp_f32 v78, v78
    s_add_u32 s57, s57, 0
    v_lshl_add_u32 v202, v1, 4, s57
    s_lshl_b32 s48, s4, 17
    s_lshl_b32 s9, s7, 16
    s_add_u32 s48, s48, s9
    s_lshl_b32 s9, s6, 10
    s_add_u32 s48, s48, s9
    s_add_u32 s48, s48, 4194304
    v_exp_f32 v79, v79
    v_cvt_pk_bf16_f32 v104, v76, v77
    v_exp_f32 v80, v80
    v_mfma_f32_32x32x16_bf16 v[132:147], v[64:67], v[112:115], v[132:147]
    v_exp_f32 v81, v81
    v_cvt_pk_bf16_f32 v105, v78, v79
    v_exp_f32 v82, v82
    v_exp_f32 v83, v83
    v_cvt_pk_bf16_f32 v106, v80, v81
    v_cvt_pk_bf16_f32 v107, v82, v83
    v_exp_f32 v84, v84
    v_exp_f32 v85, v85
    s_waitcnt vmcnt(3)
    v_exp_f32 v86, v86
    v_exp_f32 v87, v87
    v_cvt_pk_bf16_f32 v108, v84, v85
    v_mfma_f32_32x32x16_bf16 v[68:83], v[24:27], v[12:15], 0
    v_exp_f32 v88, v88
    buffer_load_dwordx4 v[32:35], v10, s[16:19], s30 offen sc1
    ds_write_b128 v202, v[152:155] offset:0
    ds_write_b128 v202, v[168:171] offset:1024
    v_exp_f32 v89, v89
    v_cvt_pk_bf16_f32 v109, v86, v87
    v_exp_f32 v90, v90
    s_mov_b64 exec, s[32:33]
    buffer_load_dwordx4 v[60:63], v11, s[16:19], s30 offen sc1
    buffer_load_dwordx4 v[64:67], v11, s[16:19], s30 offen offset:512 sc1
    s_mov_b64 exec, -1
    v_exp_f32 v91, v91
    v_cvt_pk_bf16_f32 v110, v88, v89
    v_exp_f32 v92, v92
    v_mfma_f32_32x32x16_bf16 v[116:131], v[36:39], v[100:103], v[116:131]
    s_add_u32 s30, s30, 2048
    s_and_b32 s30, s30, 0xffff
    v_exp_f32 v93, v93
    v_cvt_pk_bf16_f32 v111, v90, v91
    v_exp_f32 v94, v94
    v_exp_f32 v95, v95
    v_cvt_pk_bf16_f32 v112, v92, v93
    v_exp_f32 v96, v96
    v_mfma_f32_32x32x16_bf16 v[116:131], v[40:43], v[104:107], v[116:131]
    v_exp_f32 v97, v97
    v_cvt_pk_bf16_f32 v113, v94, v95
    v_exp_f32 v98, v98
    v_exp_f32 v99, v99
    v_cvt_pk_bf16_f32 v114, v96, v97
    v_cvt_pk_bf16_f32 v115, v98, v99
    v_exp_f32 v68, v68
    v_exp_f32 v69, v69
    v_exp_f32 v70, v70
    v_exp_f32 v71, v71
    v_cvt_pk_bf16_f32 v100, v68, v69
    v_mfma_f32_32x32x16_bf16 v[84:99], v[24:27], v[16:19], 0
    v_exp_f32 v72, v72
    ds_write_b128 v202, v[156:159] offset:8192
    ds_write_b128 v202, v[172:175] offset:9216
    v_exp_f32 v73, v73
    v_cvt_pk_bf16_f32 v101, v70, v71
    v_exp_f32 v74, v74
    v_exp_f32 v75, v75
    v_cvt_pk_bf16_f32 v102, v72, v73
    v_exp_f32 v76, v76
    v_mfma_f32_32x32x16_bf16 v[132:147], v[36:39], v[108:111], v[132:147]
    v_exp_f32 v77, v77
    v_cvt_pk_bf16_f32 v103, v74, v75
    v_exp_f32 v78, v78
    v_exp_f32 v79, v79
    v_cvt_pk_bf16_f32 v104, v76, v77
    v_exp_f32 v80, v80
    v_mfma_f32_32x32x16_bf16 v[132:147], v[40:43], v[112:115], v[132:147]
    v_exp_f32 v81, v81
    v_cvt_pk_bf16_f32 v105, v78, v79
    v_exp_f32 v82, v82
    v_exp_f32 v83, v83
    v_cvt_pk_bf16_f32 v106, v80, v81
    v_cvt_pk_bf16_f32 v107, v82, v83
    v_exp_f32 v84, v84
    v_exp_f32 v85, v85
    s_waitcnt vmcnt(3)
    v_exp_f32 v86, v86
    v_exp_f32 v87, v87
    v_cvt_pk_bf16_f32 v108, v84, v85
    v_mfma_f32_32x32x16_bf16 v[68:83], v[28:31], v[12:15], 0
    v_exp_f32 v88, v88
    buffer_load_dwordx4 v[184:187], v10, s[24:27], s48 offen sc1
    ds_write_b128 v202, v[160:163] offset:16384
    ds_write_b128 v202, v[176:179] offset:17408
    v_exp_f32 v89, v89
    v_cvt_pk_bf16_f32 v109, v86, v87
    v_exp_f32 v90, v90
    s_add_u32 s48, s48, 4096
    buffer_load_dwordx4 v[188:191], v10, s[24:27], s48 offen sc1
    s_add_u32 s48, s48, 4096
    buffer_load_dwordx4 v[192:195], v10, s[24:27], s48 offen sc1
    v_exp_f32 v91, v91
    v_cvt_pk_bf16_f32 v110, v88, v89
    v_exp_f32 v92, v92
    v_mfma_f32_32x32x16_bf16 v[116:131], v[44:47], v[100:103], v[116:131]
    s_add_u32 s48, s48, 4096
    buffer_load_dwordx4 v[196:199], v10, s[24:27], s48 offen sc1
    s_add_u32 s48, s48, 4096
    v_exp_f32 v93, v93
    v_cvt_pk_bf16_f32 v111, v90, v91
    v_exp_f32 v94, v94
    v_exp_f32 v95, v95
    v_cvt_pk_bf16_f32 v112, v92, v93
    v_exp_f32 v96, v96
    v_mfma_f32_32x32x16_bf16 v[116:131], v[48:51], v[104:107], v[116:131]
    v_exp_f32 v97, v97
    v_cvt_pk_bf16_f32 v113, v94, v95
    v_exp_f32 v98, v98
    v_exp_f32 v99, v99
    v_cvt_pk_bf16_f32 v114, v96, v97
    v_cvt_pk_bf16_f32 v115, v98, v99
    v_exp_f32 v68, v68
    v_exp_f32 v69, v69
    v_exp_f32 v70, v70
    v_exp_f32 v71, v71
    v_cvt_pk_bf16_f32 v100, v68, v69
    v_mfma_f32_32x32x16_bf16 v[84:99], v[28:31], v[16:19], 0
    v_exp_f32 v72, v72
    ds_write_b128 v202, v[164:167] offset:24576
    ds_write_b128 v202, v[180:183] offset:25600
    v_exp_f32 v73, v73
    v_cvt_pk_bf16_f32 v101, v70, v71
    v_exp_f32 v74, v74
    v_exp_f32 v75, v75
    v_cvt_pk_bf16_f32 v102, v72, v73
    v_exp_f32 v76, v76
    v_mfma_f32_32x32x16_bf16 v[132:147], v[44:47], v[108:111], v[132:147]
    v_exp_f32 v77, v77
    v_cvt_pk_bf16_f32 v103, v74, v75
    v_exp_f32 v78, v78
    v_exp_f32 v79, v79
    v_cvt_pk_bf16_f32 v104, v76, v77
    v_exp_f32 v80, v80
    v_mfma_f32_32x32x16_bf16 v[132:147], v[48:51], v[112:115], v[132:147]
    v_exp_f32 v81, v81
    v_cvt_pk_bf16_f32 v105, v78, v79
    v_exp_f32 v82, v82
    v_exp_f32 v83, v83
    v_cvt_pk_bf16_f32 v106, v80, v81
    v_cvt_pk_bf16_f32 v107, v82, v83
    v_exp_f32 v84, v84
    v_exp_f32 v85, v85
    s_waitcnt vmcnt(4)
    v_exp_f32 v86, v86
    v_exp_f32 v87, v87
    v_cvt_pk_bf16_f32 v108, v84, v85
    v_mfma_f32_32x32x16_bf16 v[68:83], v[32:35], v[12:15], 0
    v_exp_f32 v88, v88
    buffer_load_dwordx4 v[152:155], v10, s[24:27], s48 offen sc1
    v_exp_f32 v89, v89
    v_cvt_pk_bf16_f32 v109, v86, v87
    v_exp_f32 v90, v90
    s_add_u32 s48, s48, 4096
    buffer_load_dwordx4 v[156:159], v10, s[24:27], s48 offen sc1
    s_add_u32 s48, s48, 4096
    buffer_load_dwordx4 v[160:163], v10, s[24:27], s48 offen sc1
    v_exp_f32 v91, v91
    v_cvt_pk_bf16_f32 v110, v88, v89
    v_exp_f32 v92, v92
    v_mfma_f32_32x32x16_bf16 v[116:131], v[52:55], v[100:103], v[116:131]
    s_add_u32 s48, s48, 4096
    buffer_load_dwordx4 v[164:167], v10, s[24:27], s48 offen sc1
    s_add_u32 s48, s48, 4096
    v_exp_f32 v93, v93
    v_cvt_pk_bf16_f32 v111, v90, v91
    v_exp_f32 v94, v94
    v_exp_f32 v95, v95
    v_cvt_pk_bf16_f32 v112, v92, v93
    v_exp_f32 v96, v96
    v_mfma_f32_32x32x16_bf16 v[116:131], v[56:59], v[104:107], v[116:131]
    v_exp_f32 v97, v97
    v_cvt_pk_bf16_f32 v113, v94, v95
    v_exp_f32 v98, v98
    v_exp_f32 v99, v99
    v_cvt_pk_bf16_f32 v114, v96, v97
    v_cvt_pk_bf16_f32 v115, v98, v99
    v_exp_f32 v68, v68
    v_exp_f32 v69, v69
    v_exp_f32 v70, v70
    v_exp_f32 v71, v71
    v_cvt_pk_bf16_f32 v100, v68, v69
    v_mfma_f32_32x32x16_bf16 v[84:99], v[32:35], v[16:19], 0
    v_exp_f32 v72, v72
    v_exp_f32 v73, v73
    v_cvt_pk_bf16_f32 v101, v70, v71
    v_exp_f32 v74, v74
    v_exp_f32 v75, v75
    v_cvt_pk_bf16_f32 v102, v72, v73
    v_exp_f32 v76, v76
    v_mfma_f32_32x32x16_bf16 v[132:147], v[52:55], v[108:111], v[132:147]
    v_exp_f32 v77, v77
    v_cvt_pk_bf16_f32 v103, v74, v75
    v_exp_f32 v78, v78
    v_exp_f32 v79, v79
    v_cvt_pk_bf16_f32 v104, v76, v77
    v_exp_f32 v80, v80
    v_mfma_f32_32x32x16_bf16 v[132:147], v[56:59], v[112:115], v[132:147]
    v_exp_f32 v81, v81
    v_cvt_pk_bf16_f32 v105, v78, v79
    v_exp_f32 v82, v82
    v_exp_f32 v83, v83
    v_cvt_pk_bf16_f32 v106, v80, v81
    v_cvt_pk_bf16_f32 v107, v82, v83
    v_exp_f32 v84, v84
    v_exp_f32 v85, v85
    v_exp_f32 v86, v86
    v_exp_f32 v87, v87
    v_cvt_pk_bf16_f32 v108, v84, v85
    s_nop 0
    v_exp_f32 v88, v88
    buffer_load_dwordx4 v[168:171], v10, s[24:27], s48 offen sc1
    v_exp_f32 v89, v89
    v_cvt_pk_bf16_f32 v109, v86, v87
    v_exp_f32 v90, v90
    s_add_u32 s48, s48, 4096
    buffer_load_dwordx4 v[172:175], v10, s[24:27], s48 offen sc1
    s_add_u32 s48, s48, 4096
    buffer_load_dwordx4 v[176:179], v10, s[24:27], s48 offen sc1
    v_exp_f32 v91, v91
    v_cvt_pk_bf16_f32 v110, v88, v89
    v_exp_f32 v92, v92
    v_mfma_f32_32x32x16_bf16 v[116:131], v[60:63], v[100:103], v[116:131]
    s_add_u32 s48, s48, 4096
    buffer_load_dwordx4 v[180:183], v10, s[24:27], s48 offen sc1
    s_add_u32 s48, s48, 4096
    v_exp_f32 v93, v93
    v_cvt_pk_bf16_f32 v111, v90, v91
    v_exp_f32 v94, v94
    v_exp_f32 v95, v95
    v_cvt_pk_bf16_f32 v112, v92, v93
    v_exp_f32 v96, v96
    v_mfma_f32_32x32x16_bf16 v[116:131], v[64:67], v[104:107], v[116:131]
    v_exp_f32 v97, v97
    v_cvt_pk_bf16_f32 v113, v94, v95
    v_exp_f32 v98, v98
    v_exp_f32 v99, v99
    v_cvt_pk_bf16_f32 v114, v96, v97
    v_cvt_pk_bf16_f32 v115, v98, v99
    s_setprio 0
    v_mfma_f32_32x32x16_bf16 v[132:147], v[60:63], v[108:111], v[132:147]
    v_mfma_f32_32x32x16_bf16 v[132:147], v[64:67], v[112:115], v[132:147]
    s_cmp_lg_u32 s31, 0
    s_cbranch_scc1 concat_heads__softmax_full_mha__ssm_conv_s4d__prompt_kernel_slow
concat_heads__softmax_full_mha__ssm_conv_s4d__prompt_kernel_fin:
    v_lshlrev_b32 v2, 4, v1
    s_mul_i32 s10, s5, 3072
    s_add_u32 s10, s10, 65536
    v_add_u32 v3, s10, v2
    s_xor_b32 s11, s5, 4
    s_mul_i32 s11, s11, 3072
    s_add_u32 s11, s11, 65536
    v_add_u32 v4, s11, v2
    s_nop 1
    v_mov_b32 v68, v140
    v_mov_b32 v69, v149
    ds_write_b128 v3, v[132:135]
    ds_write_b128 v3, v[136:139] offset:1024
    ds_write_b64 v3, v[68:69] offset:2048
    s_lshr_b32 s54, s5, 2
    s_and_b32 s55, s5, 3
    s_lshl_b32 s56, s54, 15
    s_lshl_b32 s57, s55, 13
    s_add_u32 s57, s57, s56
    s_add_u32 s57, s57, 0
    v_and_b32 v7, 31, v1
    v_lshlrev_b32 v7, 6, v7
    v_lshrrev_b32 v6, 5, v1
    v_lshl_add_u32 v7, v6, 3, v7
    s_lshl_b32 s56, s54, 12
    s_lshl_b32 s54, s55, 4
    s_add_u32 s56, s56, s54
    s_add_u32 s56, s56, 90112
    v_add_u32 v7, s56, v7
    v_lshl_add_u32 v6, v1, 4, s57
    s_waitcnt lgkmcnt(0)
    s_barrier
    ds_read_b128 v[72:75], v4
    ds_read_b128 v[76:79], v4 offset:1024
    ds_read_b64 v[80:81], v4 offset:2048
    ds_read_b128 v[20:23], v6 offset:0
    ds_read_b128 v[24:27], v6 offset:1024
    ds_read_b128 v[28:31], v6 offset:2048
    ds_read_b128 v[32:35], v6 offset:3072
    ds_read_b128 v[36:39], v6 offset:4096
    ds_read_b128 v[40:43], v6 offset:5120
    ds_read_b128 v[44:47], v6 offset:6144
    ds_read_b128 v[48:51], v6 offset:7168
    s_waitcnt lgkmcnt(8)
    v_max_f32 v5, v148, v81
    v_sub_f32 v3, v148, v5
    v_sub_f32 v4, v81, v5
    v_exp_f32 v3, v3
    v_exp_f32 v4, v4
    v_mul_f32 v5, v3, v124
    v_fmac_f32 v5, v4, v80
    v_rcp_f32 v5, v5
    s_nop 0
    v_mul_f32 v3, v3, v5
    v_mul_f32 v4, v4, v5
    v_mul_f32 v116, v3, v116
    v_fmac_f32 v116, v4, v72
    v_mul_f32 v117, v3, v117
    v_fmac_f32 v117, v4, v73
    v_mul_f32 v118, v3, v118
    v_fmac_f32 v118, v4, v74
    v_mul_f32 v119, v3, v119
    v_fmac_f32 v119, v4, v75
    v_mul_f32 v120, v3, v120
    v_fmac_f32 v120, v4, v76
    v_mul_f32 v121, v3, v121
    v_fmac_f32 v121, v4, v77
    v_mul_f32 v122, v3, v122
    v_fmac_f32 v122, v4, v78
    v_mul_f32 v123, v3, v123
    v_fmac_f32 v123, v4, v79
    v_cvt_pk_bf16_f32 v100, v116, v117
    v_cvt_pk_bf16_f32 v101, v118, v119
    v_cvt_pk_bf16_f32 v102, v120, v121
    v_cvt_pk_bf16_f32 v103, v122, v123
    s_lshl_b32 s10, s3, 1
    s_add_u32 s10, s10, s7
    s_lshl_b32 s10, s10, 5
    s_lshl_b32 s11, s4, 2
    s_add_u32 s10, s10, s11
    s_add_u32 s10, s10, s6
    s_lshl_b32 s10, s10, 10
    s_add_u32 s10, s10, 8388608
    buffer_store_dwordx4 v[100:103], v10, s[24:27], s10 offen sc1
    s_waitcnt lgkmcnt(0)
    v_add_f32 v20, v20, v28
    v_add_f32 v36, v36, v44
    v_add_f32 v21, v21, v29
    v_add_f32 v37, v37, v45
    v_add_f32 v22, v22, v30
    v_add_f32 v38, v38, v46
    v_add_f32 v23, v23, v31
    v_add_f32 v39, v39, v47
    v_add_f32 v24, v24, v32
    v_add_f32 v40, v40, v48
    v_add_f32 v25, v25, v33
    v_add_f32 v41, v41, v49
    v_add_f32 v26, v26, v34
    v_add_f32 v42, v42, v50
    v_add_f32 v27, v27, v35
    v_add_f32 v43, v43, v51
    v_add_f32 v20, v20, v36
    v_add_f32 v21, v21, v37
    v_add_f32 v22, v22, v38
    v_add_f32 v23, v23, v39
    v_add_f32 v24, v24, v40
    v_add_f32 v25, v25, v41
    v_add_f32 v26, v26, v42
    v_add_f32 v27, v27, v43
    v_cvt_pk_bf16_f32 v36, v20, v21
    v_cvt_pk_bf16_f32 v37, v22, v23
    v_cvt_pk_bf16_f32 v38, v24, v25
    v_cvt_pk_bf16_f32 v39, v26, v27
    ds_write_b64 v7, v[36:37]
    ds_write_b64 v7, v[38:39] offset:2048
    s_waitcnt lgkmcnt(0)
    s_barrier
    v_lshlrev_b32 v2, 4, v0
    v_add_u32 v3, 90112, v2
    ds_read_b128 v[20:23], v3
    s_lshl_b32 s54, s4, 6
    s_lshl_b32 s55, s3, 1
    s_add_u32 s54, s54, s55
    s_lshl_b32 s54, s54, 12
    s_add_u32 s54, s54, 10485760
    s_waitcnt lgkmcnt(0)
    buffer_store_dwordx4 v[20:23], v2, s[24:27], s54 offen sc1
    s_and_b32 s50, s5, 3
    s_lshr_b32 s51, s5, 2
    s_waitcnt vmcnt(1)
    s_barrier
    s_cmp_eq_u32 s5, 4
    s_cbranch_scc1 concat_heads__softmax_full_mha__ssm_conv_s4d__prompt_kernel_w0a
    s_waitcnt vmcnt(0)
    s_barrier
    s_branch concat_heads__softmax_full_mha__ssm_conv_s4d__prompt_kernel_w0b
concat_heads__softmax_full_mha__ssm_conv_s4d__prompt_kernel_w0a:
    s_lshl_b32 s49, s3, 3
    s_add_u32 s49, s49, s4
    s_lshl_b32 s8, s49, 6
    s_add_u32 s8, s8, 14712832
    v_mov_b32 v2, s98
    v_mov_b32 v3, s99
    v_mov_b32 v4, 0
    s_mov_b64 s[10:11], exec
    s_mov_b64 exec, 1
    buffer_store_dwordx2 v[2:3], v4, s[24:27], s8 offen sc1
    s_mov_b64 exec, s[10:11]
    s_waitcnt vmcnt(1)
    s_barrier
    s_lshl_b32 s53, s4, 5
    s_add_u32 s53, s53, s3
    s_lshl_b32 s8, s53, 6
    s_add_u32 s8, s8, 14729216
    v_mov_b32 v2, s98
    v_mov_b32 v3, s99
    v_mov_b32 v4, 0
    s_mov_b64 s[10:11], exec
    s_mov_b64 exec, 1
    buffer_store_dwordx2 v[2:3], v4, s[24:27], s8 offen sc1
    s_mov_b64 exec, s[10:11]
concat_heads__softmax_full_mha__ssm_conv_s4d__prompt_kernel_w0b:
    buffer_load_dwordx4 v[68:71], v10, s[24:27], s48 offen sc1
    s_add_u32 s48, s48, 4096
    buffer_load_dwordx4 v[72:75], v10, s[24:27], s48 offen sc1
    s_add_u32 s48, s48, 4096
    buffer_load_dwordx4 v[76:79], v10, s[24:27], s48 offen sc1
    s_add_u32 s48, s48, 4096
    buffer_load_dwordx4 v[80:83], v10, s[24:27], s48 offen sc1
    s_add_u32 s48, s48, 4096
    s_lshl_b32 s52, s3, 1
    s_and_b32 s10, s4, 1
    s_add_u32 s52, s52, s10
    s_lshr_b32 s54, s4, 1
    s_mov_b32 s12, s66
    s_and_b32 s13, s67, 0xffff
    s_mov_b32 s14, 0x400000
    s_mov_b32 s15, 0x20000
    s_lshl_b32 s10, s51, 14
    s_add_u32 s10, s10, 65536
    v_add_u32 v15, s10, v10
    s_cmp_ge_u32 s5, 4
    s_cbranch_scc1 concat_heads__softmax_full_mha__ssm_conv_s4d__prompt_kernel_yw
    v_mov_b32 v6, 163616
    s_cmp_eq_u32 s5, 1
    s_cbranch_scc0 concat_heads__softmax_full_mha__ssm_conv_s4d__prompt_kernel_osp
    s_lshl_b32 s55, s3, 3
    s_lshl_b32 s8, s55, 6
    s_add_u32 s8, s8, 14712832
    v_lshlrev_b32 v4, 6, v1
    s_mov_b64 s[10:11], exec
    s_mov_b64 exec, 0xff
    s_mov_b32 s9, 0x40000
concat_heads__softmax_full_mha__ssm_conv_s4d__prompt_kernel_plo:
    buffer_load_dwordx2 v[2:3], v4, s[24:27], s8 offen sc1
    s_waitcnt vmcnt(0)
    v_cmp_eq_u32 vcc, s98, v2
    v_cmp_eq_u32 s[100:101], s99, v3
    s_sub_u32 s9, s9, 1
    s_cmp_eq_u32 s9, 0
    s_cbranch_scc1 concat_heads__softmax_full_mha__ssm_conv_s4d__prompt_kernel_plo_x
    s_and_b64 vcc, vcc, s[100:101]
    s_cmp_eq_u64 vcc, exec
    s_cbranch_scc0 concat_heads__softmax_full_mha__ssm_conv_s4d__prompt_kernel_plo
concat_heads__softmax_full_mha__ssm_conv_s4d__prompt_kernel_plo_x:
    s_mov_b64 exec, s[10:11]
    v_mov_b32 v7, 1
    ds_write_b32 v6, v7
    s_branch concat_heads__softmax_full_mha__ssm_conv_s4d__prompt_kernel_ogo
concat_heads__softmax_full_mha__ssm_conv_s4d__prompt_kernel_osp:
    s_mov_b32 s9, 0x400000
concat_heads__softmax_full_mha__ssm_conv_s4d__prompt_kernel_osl:
    ds_read_b32 v7, v6
    s_waitcnt lgkmcnt(0)
    v_readfirstlane_b32 s8, v7
    s_sub_u32 s9, s9, 1
    s_cmp_eq_u32 s9, 0
    s_cbranch_scc1 concat_heads__softmax_full_mha__ssm_conv_s4d__prompt_kernel_ogo
    s_cmp_eq_u32 s8, 0
    s_cbranch_scc1 concat_heads__softmax_full_mha__ssm_conv_s4d__prompt_kernel_osl
concat_heads__softmax_full_mha__ssm_conv_s4d__prompt_kernel_ogo:
    s_lshl_b32 s10, s52, 15
    s_add_u32 s10, s10, 8388608
    s_lshl_b32 s11, s5, 13
    s_add_u32 s10, s10, s11
    s_add_u32 s11, s11, 65536
    s_add_u32 m0, s11, 0
    s_add_u32 s35, s10, 0
    buffer_load_dwordx4 v10, s[24:27], s35 offen sc1 lds
    s_add_u32 m0, s11, 1024
    s_add_u32 s35, s10, 1024
    buffer_load_dwordx4 v10, s[24:27], s35 offen sc1 lds
    s_add_u32 m0, s11, 2048
    s_add_u32 s35, s10, 2048
    buffer_load_dwordx4 v10, s[24:27], s35 offen sc1 lds
    s_add_u32 m0, s11, 3072
    s_add_u32 s35, s10, 3072
    buffer_load_dwordx4 v10, s[24:27], s35 offen sc1 lds
    s_add_u32 m0, s11, 4096
    s_add_u32 s35, s10, 4096
    buffer_load_dwordx4 v10, s[24:27], s35 offen sc1 lds
    s_add_u32 m0, s11, 5120
    s_add_u32 s35, s10, 5120
    buffer_load_dwordx4 v10, s[24:27], s35 offen sc1 lds
    s_add_u32 m0, s11, 6144
    s_add_u32 s35, s10, 6144
    buffer_load_dwordx4 v10, s[24:27], s35 offen sc1 lds
    s_add_u32 m0, s11, 7168
    s_add_u32 s35, s10, 7168
    buffer_load_dwordx4 v10, s[24:27], s35 offen sc1 lds
    s_waitcnt vmcnt(0)
    s_cmp_lg_u32 s5, 0
    s_cbranch_scc1 concat_heads__softmax_full_mha__ssm_conv_s4d__prompt_kernel_po
    s_cmp_lg_u32 s2, 0
    s_cbranch_scc1 concat_heads__softmax_full_mha__ssm_conv_s4d__prompt_kernel_ne
    v_mov_b32 v2, s98
    v_mov_b32 v3, s99
    v_mov_b32 v4, 0
    s_mov_b32 s8, 14745600
    s_mov_b64 exec, 1
    buffer_store_dwordx2 v[2:3], v4, s[24:27], s8 offen sc1
    s_mov_b64 exec, -1
concat_heads__softmax_full_mha__ssm_conv_s4d__prompt_kernel_ne:
concat_heads__softmax_full_mha__ssm_conv_s4d__prompt_kernel_po:
    s_branch concat_heads__softmax_full_mha__ssm_conv_s4d__prompt_kernel_yj
concat_heads__softmax_full_mha__ssm_conv_s4d__prompt_kernel_yw:
    s_cmp_eq_u32 s5, 5
    s_cbranch_scc0 concat_heads__softmax_full_mha__ssm_conv_s4d__prompt_kernel_yn
    s_and_b32 s56, s3, 3
    s_lshl_b32 s55, s4, 5
    s_lshl_b32 s57, s56, 3
    s_add_u32 s55, s55, s57
    s_lshl_b32 s8, s55, 6
    s_add_u32 s8, s8, 14729216
    v_lshlrev_b32 v4, 6, v1
    s_mov_b64 s[10:11], exec
    s_mov_b64 exec, 0xff
    s_mov_b32 s9, 0x40000
concat_heads__softmax_full_mha__ssm_conv_s4d__prompt_kernel_ply:
    buffer_load_dwordx2 v[2:3], v4, s[24:27], s8 offen sc1
    s_waitcnt vmcnt(0)
    v_cmp_eq_u32 vcc, s98, v2
    v_cmp_eq_u32 s[100:101], s99, v3
    s_sub_u32 s9, s9, 1
    s_cmp_eq_u32 s9, 0
    s_cbranch_scc1 concat_heads__softmax_full_mha__ssm_conv_s4d__prompt_kernel_ply_x
    s_and_b64 vcc, vcc, s[100:101]
    s_cmp_eq_u64 vcc, exec
    s_cbranch_scc0 concat_heads__softmax_full_mha__ssm_conv_s4d__prompt_kernel_ply
concat_heads__softmax_full_mha__ssm_conv_s4d__prompt_kernel_ply_x:
    s_mov_b64 exec, s[10:11]
    s_and_b32 s56, s3, 3
    s_lshl_b32 s56, s56, 4
    s_lshl_b32 s10, s4, 6
    s_add_u32 s10, s10, s56
    v_lshrrev_b32 v2, 5, v1
    v_add_u32 v2, s10, v2
    v_lshlrev_b32 v8, 12, v2
    v_and_b32 v2, 31, v1
    v_lshl_add_u32 v8, v2, 4, v8
    s_lshr_b32 s53, s3, 2
    s_lshl_b32 s53, s53, 9
    s_add_u32 s53, s53, 10485760
    buffer_load_dwordx4 v[84:87], v8, s[24:27], s53 offen sc1
    s_add_u32 s53, s53, 8192
    buffer_load_dwordx4 v[88:91], v8, s[24:27], s53 offen sc1
    s_add_u32 s53, s53, 8192
    buffer_load_dwordx4 v[92:95], v8, s[24:27], s53 offen sc1
    s_add_u32 s53, s53, 8192
    buffer_load_dwordx4 v[96:99], v8, s[24:27], s53 offen sc1
    s_add_u32 s53, s53, 8192
    buffer_load_dwordx4 v[100:103], v8, s[24:27], s53 offen sc1
    s_add_u32 s53, s53, 8192
    buffer_load_dwordx4 v[104:107], v8, s[24:27], s53 offen sc1
    s_add_u32 s53, s53, 8192
    buffer_load_dwordx4 v[108:111], v8, s[24:27], s53 offen sc1
    s_add_u32 s53, s53, 8192
    buffer_load_dwordx4 v[112:115], v8, s[24:27], s53 offen sc1
    s_waitcnt vmcnt(8)
    s_branch concat_heads__softmax_full_mha__ssm_conv_s4d__prompt_kernel_yj
concat_heads__softmax_full_mha__ssm_conv_s4d__prompt_kernel_yn:
    s_waitcnt vmcnt(0)
concat_heads__softmax_full_mha__ssm_conv_s4d__prompt_kernel_yj:
    s_barrier
    ds_read_b128 v[32:35], v15 offset:0
    ds_read_b128 v[36:39], v15 offset:1024
    ds_read_b128 v[40:43], v15 offset:2048
    ds_read_b128 v[44:47], v15 offset:3072
    ds_read_b128 v[48:51], v15 offset:4096
    ds_read_b128 v[52:55], v15 offset:5120
    ds_read_b128 v[56:59], v15 offset:6144
    ds_read_b128 v[60:63], v15 offset:7168
    s_waitcnt lgkmcnt(7)
    v_mfma_f32_32x32x16_bf16 v[136:151], v[184:187], v[32:35], 0
    ds_read_b128 v[32:35], v15 offset:8192
    s_waitcnt lgkmcnt(7)
    v_mfma_f32_32x32x16_bf16 v[136:151], v[188:191], v[36:39], v[136:151]
    ds_read_b128 v[36:39], v15 offset:9216
    s_waitcnt lgkmcnt(7)
    v_mfma_f32_32x32x16_bf16 v[136:151], v[192:195], v[40:43], v[136:151]
    ds_read_b128 v[40:43], v15 offset:10240
    s_waitcnt lgkmcnt(7)
    v_mfma_f32_32x32x16_bf16 v[136:151], v[196:199], v[44:47], v[136:151]
    ds_read_b128 v[44:47], v15 offset:11264
    s_waitcnt lgkmcnt(7)
    v_mfma_f32_32x32x16_bf16 v[136:151], v[152:155], v[48:51], v[136:151]
    ds_read_b128 v[48:51], v15 offset:12288
    s_waitcnt lgkmcnt(7)
    v_mfma_f32_32x32x16_bf16 v[136:151], v[156:159], v[52:55], v[136:151]
    ds_read_b128 v[52:55], v15 offset:13312
    s_waitcnt lgkmcnt(7)
    v_mfma_f32_32x32x16_bf16 v[136:151], v[160:163], v[56:59], v[136:151]
    ds_read_b128 v[56:59], v15 offset:14336
    s_waitcnt lgkmcnt(7)
    v_mfma_f32_32x32x16_bf16 v[136:151], v[164:167], v[60:63], v[136:151]
    ds_read_b128 v[60:63], v15 offset:15360
    s_waitcnt lgkmcnt(7)
    v_mfma_f32_32x32x16_bf16 v[136:151], v[168:171], v[32:35], v[136:151]
    s_waitcnt lgkmcnt(6)
    v_mfma_f32_32x32x16_bf16 v[136:151], v[172:175], v[36:39], v[136:151]
    s_waitcnt lgkmcnt(5)
    v_mfma_f32_32x32x16_bf16 v[136:151], v[176:179], v[40:43], v[136:151]
    s_waitcnt lgkmcnt(4)
    v_mfma_f32_32x32x16_bf16 v[136:151], v[180:183], v[44:47], v[136:151]
    s_waitcnt lgkmcnt(3)
    v_mfma_f32_32x32x16_bf16 v[136:151], v[68:71], v[48:51], v[136:151]
    s_waitcnt lgkmcnt(2)
    v_mfma_f32_32x32x16_bf16 v[136:151], v[72:75], v[52:55], v[136:151]
    s_waitcnt lgkmcnt(1)
    v_mfma_f32_32x32x16_bf16 v[136:151], v[76:79], v[56:59], v[136:151]
    s_waitcnt lgkmcnt(0)
    v_mfma_f32_32x32x16_bf16 v[136:151], v[80:83], v[60:63], v[136:151]
    v_lshlrev_b32 v2, 4, v1
    s_lshl_b32 s10, s5, 11
    v_add_u32 v3, s10, v2
    s_xor_b32 s11, s5, 4
    s_lshl_b32 s11, s11, 11
    v_add_u32 v4, s11, v2
    s_cmp_lg_u32 s5, 5
    s_cbranch_scc1 concat_heads__softmax_full_mha__ssm_conv_s4d__prompt_kernel_ysc
    v_lshrrev_b32 v2, 5, v1
    v_mul_u32_u24 v2, 516, v2
    v_and_b32 v5, 31, v1
    v_lshl_add_u32 v2, v5, 4, v2
    v_add_u32 v2, 146944, v2
    s_waitcnt vmcnt(7)
    ds_write_b32 v2, v84 offset:0
    ds_write_b32 v2, v85 offset:4
    ds_write_b32 v2, v86 offset:8
    ds_write_b32 v2, v87 offset:12
    s_waitcnt vmcnt(6)
    ds_write_b32 v2, v88 offset:1032
    ds_write_b32 v2, v89 offset:1036
    ds_write_b32 v2, v90 offset:1040
    ds_write_b32 v2, v91 offset:1044
    s_waitcnt vmcnt(5)
    ds_write_b32 v2, v92 offset:2064
    ds_write_b32 v2, v93 offset:2068
    ds_write_b32 v2, v94 offset:2072
    ds_write_b32 v2, v95 offset:2076
    s_waitcnt vmcnt(4)
    ds_write_b32 v2, v96 offset:3096
    ds_write_b32 v2, v97 offset:3100
    ds_write_b32 v2, v98 offset:3104
    ds_write_b32 v2, v99 offset:3108
    s_waitcnt vmcnt(3)
    ds_write_b32 v2, v100 offset:4128
    ds_write_b32 v2, v101 offset:4132
    ds_write_b32 v2, v102 offset:4136
    ds_write_b32 v2, v103 offset:4140
    s_waitcnt vmcnt(2)
    ds_write_b32 v2, v104 offset:5160
    ds_write_b32 v2, v105 offset:5164
    ds_write_b32 v2, v106 offset:5168
    ds_write_b32 v2, v107 offset:5172
    s_waitcnt vmcnt(1)
    ds_write_b32 v2, v108 offset:6192
    ds_write_b32 v2, v109 offset:6196
    ds_write_b32 v2, v110 offset:6200
    ds_write_b32 v2, v111 offset:6204
    s_waitcnt vmcnt(0)
    ds_write_b32 v2, v112 offset:7224
    ds_write_b32 v2, v113 offset:7228
    ds_write_b32 v2, v114 offset:7232
    ds_write_b32 v2, v115 offset:7236
concat_heads__softmax_full_mha__ssm_conv_s4d__prompt_kernel_ysc:
    s_cmp_eq_u32 s51, 1
    s_cbranch_scc1 concat_heads__softmax_full_mha__ssm_conv_s4d__prompt_kernel_kq1
    s_nop 1
    ds_write_b128 v3, v[144:147]
    ds_write_b128 v3, v[148:151] offset:1024
    v_mov_b32 v40, v136
    v_mov_b32 v41, v137
    v_mov_b32 v42, v138
    v_mov_b32 v43, v139
    v_mov_b32 v44, v140
    v_mov_b32 v45, v141
    v_mov_b32 v46, v142
    v_mov_b32 v47, v143
    s_branch concat_heads__softmax_full_mha__ssm_conv_s4d__prompt_kernel_kqj
concat_heads__softmax_full_mha__ssm_conv_s4d__prompt_kernel_kq1:
    s_nop 1
    ds_write_b128 v3, v[136:139]
    ds_write_b128 v3, v[140:143] offset:1024
    v_mov_b32 v40, v144
    v_mov_b32 v41, v145
    v_mov_b32 v42, v146
    v_mov_b32 v43, v147
    v_mov_b32 v44, v148
    v_mov_b32 v45, v149
    v_mov_b32 v46, v150
    v_mov_b32 v47, v151
concat_heads__softmax_full_mha__ssm_conv_s4d__prompt_kernel_kqj:
    s_waitcnt lgkmcnt(0)
    s_barrier
    ds_read_b128 v[32:35], v4
    ds_read_b128 v[36:39], v4 offset:1024
    v_and_b32 v2, 1, v0
    v_mul_u32_u24 v2, 4128, v2
    v_lshrrev_b32 v3, 1, v0
    v_lshl_add_u32 v2, v3, 1, v2
    v_add_u32 v2, 146944, v2
    ds_read_u16_d16 v56, v2 offset:0
    ds_read_u16_d16_hi v57, v2 offset:516
    ds_read_u16_d16 v58, v2 offset:1032
    ds_read_u16_d16_hi v59, v2 offset:1548
    ds_read_u16_d16 v60, v2 offset:2064
    ds_read_u16_d16_hi v61, v2 offset:2580
    ds_read_u16_d16 v62, v2 offset:3096
    ds_read_u16_d16_hi v63, v2 offset:3612
    s_waitcnt lgkmcnt(8)
    v_add_f32 v32, v32, v40
    v_add_f32 v33, v33, v41
    v_add_f32 v34, v34, v42
    v_add_f32 v35, v35, v43
    v_add_f32 v36, v36, v44
    v_add_f32 v37, v37, v45
    v_add_f32 v38, v38, v46
    v_add_f32 v39, v39, v47
    v_cvt_pk_bf16_f32 v48, v32, v33
    v_cvt_pk_bf16_f32 v49, v34, v35
    v_cvt_pk_bf16_f32 v50, v36, v37
    v_cvt_pk_bf16_f32 v51, v38, v39
    s_nop 0
    v_permlane32_swap_b32 v48, v50
    v_permlane32_swap_b32 v49, v51
    v_and_b32 v2, 31, v1
    v_lshlrev_b32 v2, 11, v2
    v_lshrrev_b32 v4, 5, v1
    v_lshl_add_u32 v2, v4, 4, v2
    s_lshl_b32 s10, s52, 16
    s_lshl_b32 s11, s54, 8
    s_add_u32 s10, s10, s11
    s_lshl_b32 s11, s50, 6
    s_add_u32 s10, s10, s11
    s_lshl_b32 s11, s51, 5
    s_add_u32 s10, s10, s11
    buffer_store_dwordx4 v[48:51], v2, s[12:15], s10 offen
    s_lshr_b32 s10, s3, 2
    s_lshl_b32 s10, s10, 8
    v_add_u32 v3, s10, v3
    v_lshlrev_b32 v3, 11, v3
    v_and_b32 v4, 1, v0
    v_lshl_add_u32 v3, v4, 4, v3
    s_lshl_b32 s10, s4, 7
    s_and_b32 s11, s3, 3
    s_lshl_b32 s11, s11, 5
    s_add_u32 s10, s10, s11
    s_add_u32 s10, s10, 1024
    s_waitcnt lgkmcnt(0)
    v_or_b32 v20, v56, v57
    v_or_b32 v21, v58, v59
    v_or_b32 v22, v60, v61
    v_or_b32 v23, v62, v63
    buffer_store_dwordx4 v[20:23], v3, s[12:15], s10 offen
concat_heads__softmax_full_mha__ssm_conv_s4d__prompt_kernel_end:
    s_endpgm
concat_heads__softmax_full_mha__ssm_conv_s4d__prompt_kernel_slow:
    s_waitcnt vmcnt(0)
    s_lshl_b32 s30, s3, 11
    buffer_load_dwordx4 v[20:23], v10, s[16:19], s30 offen sc1
    s_mov_b64 exec, s[32:33]
    buffer_load_dwordx4 v[36:39], v11, s[16:19], s30 offen sc1
    buffer_load_dwordx4 v[40:43], v11, s[16:19], s30 offen offset:512 sc1
    s_mov_b64 exec, -1
    s_add_u32 s30, s30, 2048
    s_and_b32 s30, s30, 0xffff
    buffer_load_dwordx4 v[24:27], v10, s[16:19], s30 offen sc1
    s_mov_b64 exec, s[32:33]
    buffer_load_dwordx4 v[44:47], v11, s[16:19], s30 offen sc1
    buffer_load_dwordx4 v[48:51], v11, s[16:19], s30 offen offset:512 sc1
    s_mov_b64 exec, -1
    s_add_u32 s30, s30, 2048
    s_and_b32 s30, s30, 0xffff
    buffer_load_dwordx4 v[28:31], v10, s[16:19], s30 offen sc1
    s_mov_b64 exec, s[32:33]
    buffer_load_dwordx4 v[52:55], v11, s[16:19], s30 offen sc1
    buffer_load_dwordx4 v[56:59], v11, s[16:19], s30 offen offset:512 sc1
    s_mov_b64 exec, -1
    s_add_u32 s30, s30, 2048
    s_and_b32 s30, s30, 0xffff
    v_mov_b32 v116, 0
    v_mov_b32 v117, 0
    v_mov_b32 v118, 0
    v_mov_b32 v119, 0
    v_mov_b32 v120, 0
    v_mov_b32 v121, 0
    v_mov_b32 v122, 0
    v_mov_b32 v123, 0
    v_mov_b32 v124, 0
    v_mov_b32 v125, 0
    v_mov_b32 v126, 0
    v_mov_b32 v127, 0
    v_mov_b32 v128, 0
    v_mov_b32 v129, 0
    v_mov_b32 v130, 0
    v_mov_b32 v131, 0
    v_mov_b32 v132, 0
    v_mov_b32 v133, 0
    v_mov_b32 v134, 0
    v_mov_b32 v135, 0
    v_mov_b32 v136, 0
    v_mov_b32 v137, 0
    v_mov_b32 v138, 0
    v_mov_b32 v139, 0
    v_mov_b32 v140, 0
    v_mov_b32 v141, 0
    v_mov_b32 v142, 0
    v_mov_b32 v143, 0
    v_mov_b32 v144, 0
    v_mov_b32 v145, 0
    v_mov_b32 v146, 0
    v_mov_b32 v147, 0
    v_mov_b32 v108, 0
    v_mov_b32 v109, 0
    v_mov_b32 v110, 0
    v_mov_b32 v111, 0
    v_mov_b32 v112, 0
    v_mov_b32 v113, 0
    v_mov_b32 v114, 0
    v_mov_b32 v115, 0
    s_mov_b64 exec, s[32:33]
    v_mov_b32 v60, 0
    v_mov_b32 v61, 0
    v_mov_b32 v62, 0
    v_mov_b32 v63, 0
    v_mov_b32 v64, 0
    v_mov_b32 v65, 0
    v_mov_b32 v66, 0
    v_mov_b32 v67, 0
    s_mov_b64 exec, -1
    v_mov_b32 v148, 0xff7fffff
    v_mov_b32 v149, 0xff7fffff
    s_waitcnt vmcnt(6)
    v_mfma_f32_32x32x16_bf16 v[68:83], v[20:23], v[12:15], 0
    s_mov_b32 s34, 8
concat_heads__softmax_full_mha__ssm_conv_s4d__prompt_kernel_sloop:
    s_nop 10
    v_max3_f32 v2, v68, v69, v70
    v_max3_f32 v2, v2, v71, v72
    v_max3_f32 v2, v2, v73, v74
    v_max3_f32 v2, v2, v75, v76
    v_max3_f32 v2, v2, v77, v78
    v_max3_f32 v2, v2, v79, v80
    v_max3_f32 v2, v2, v81, v82
    v_max_f32 v2, v2, v83
    v_mov_b32 v3, v2
    s_nop 1
    v_permlane32_swap_b32 v2, v3
    v_max_f32 v2, v2, v3
    v_max_f32 v2, v2, v148
    v_sub_f32 v3, v148, v2
    v_mov_b32 v148, v2
    v_exp_f32 v3, v3
    v_sub_f32 v68, v68, v2
    v_sub_f32 v69, v69, v2
    v_sub_f32 v70, v70, v2
    v_sub_f32 v71, v71, v2
    v_sub_f32 v72, v72, v2
    v_sub_f32 v73, v73, v2
    v_sub_f32 v74, v74, v2
    v_sub_f32 v75, v75, v2
    v_sub_f32 v76, v76, v2
    v_sub_f32 v77, v77, v2
    v_sub_f32 v78, v78, v2
    v_sub_f32 v79, v79, v2
    v_sub_f32 v80, v80, v2
    v_sub_f32 v81, v81, v2
    v_sub_f32 v82, v82, v2
    v_sub_f32 v83, v83, v2
    v_mul_f32 v116, v3, v116
    v_mul_f32 v117, v3, v117
    v_mul_f32 v118, v3, v118
    v_mul_f32 v119, v3, v119
    v_mul_f32 v120, v3, v120
    v_mul_f32 v121, v3, v121
    v_mul_f32 v122, v3, v122
    v_mul_f32 v123, v3, v123
    v_mul_f32 v124, v3, v124
    v_mfma_f32_32x32x16_bf16 v[84:99], v[20:23], v[16:19], 0
    v_exp_f32 v68, v68
    v_exp_f32 v69, v69
    v_exp_f32 v70, v70
    v_exp_f32 v71, v71
    v_exp_f32 v72, v72
    v_exp_f32 v73, v73
    v_exp_f32 v74, v74
    v_exp_f32 v75, v75
    v_exp_f32 v76, v76
    v_exp_f32 v77, v77
    v_exp_f32 v78, v78
    v_exp_f32 v79, v79
    v_exp_f32 v80, v80
    v_exp_f32 v81, v81
    v_exp_f32 v82, v82
    v_exp_f32 v83, v83
    v_mfma_f32_32x32x16_bf16 v[132:147], v[60:63], v[108:111], v[132:147]
    v_mfma_f32_32x32x16_bf16 v[132:147], v[64:67], v[112:115], v[132:147]
    v_cvt_pk_bf16_f32 v100, v68, v69
    v_cvt_pk_bf16_f32 v101, v70, v71
    v_cvt_pk_bf16_f32 v102, v72, v73
    v_cvt_pk_bf16_f32 v103, v74, v75
    v_cvt_pk_bf16_f32 v104, v76, v77
    v_cvt_pk_bf16_f32 v105, v78, v79
    v_cvt_pk_bf16_f32 v106, v80, v81
    v_cvt_pk_bf16_f32 v107, v82, v83
    v_max3_f32 v2, v84, v85, v86
    v_max3_f32 v2, v2, v87, v88
    v_max3_f32 v2, v2, v89, v90
    v_max3_f32 v2, v2, v91, v92
    v_max3_f32 v2, v2, v93, v94
    v_max3_f32 v2, v2, v95, v96
    v_max3_f32 v2, v2, v97, v98
    v_max_f32 v2, v2, v99
    v_mov_b32 v3, v2
    s_nop 1
    v_permlane32_swap_b32 v2, v3
    v_max_f32 v2, v2, v3
    v_max_f32 v2, v2, v149
    v_sub_f32 v3, v149, v2
    v_mov_b32 v149, v2
    v_exp_f32 v3, v3
    v_sub_f32 v84, v84, v2
    v_sub_f32 v85, v85, v2
    v_sub_f32 v86, v86, v2
    v_sub_f32 v87, v87, v2
    v_sub_f32 v88, v88, v2
    v_sub_f32 v89, v89, v2
    v_sub_f32 v90, v90, v2
    v_sub_f32 v91, v91, v2
    v_sub_f32 v92, v92, v2
    v_sub_f32 v93, v93, v2
    v_sub_f32 v94, v94, v2
    v_sub_f32 v95, v95, v2
    v_sub_f32 v96, v96, v2
    v_sub_f32 v97, v97, v2
    v_sub_f32 v98, v98, v2
    v_sub_f32 v99, v99, v2
    v_mul_f32 v132, v3, v132
    v_mul_f32 v133, v3, v133
    v_mul_f32 v134, v3, v134
    v_mul_f32 v135, v3, v135
    v_mul_f32 v136, v3, v136
    v_mul_f32 v137, v3, v137
    v_mul_f32 v138, v3, v138
    v_mul_f32 v139, v3, v139
    v_mul_f32 v140, v3, v140
    s_waitcnt vmcnt(3)
    v_mfma_f32_32x32x16_bf16 v[68:83], v[24:27], v[12:15], 0
    v_exp_f32 v84, v84
    v_exp_f32 v85, v85
    v_exp_f32 v86, v86
    v_exp_f32 v87, v87
    v_exp_f32 v88, v88
    v_exp_f32 v89, v89
    v_exp_f32 v90, v90
    v_exp_f32 v91, v91
    v_exp_f32 v92, v92
    v_exp_f32 v93, v93
    v_exp_f32 v94, v94
    v_exp_f32 v95, v95
    v_exp_f32 v96, v96
    v_exp_f32 v97, v97
    v_exp_f32 v98, v98
    v_exp_f32 v99, v99
    buffer_load_dwordx4 v[32:35], v10, s[16:19], s30 offen sc1
    s_mov_b64 exec, s[32:33]
    buffer_load_dwordx4 v[60:63], v11, s[16:19], s30 offen sc1
    buffer_load_dwordx4 v[64:67], v11, s[16:19], s30 offen offset:512 sc1
    s_mov_b64 exec, -1
    s_add_u32 s30, s30, 2048
    s_and_b32 s30, s30, 0xffff
    v_mfma_f32_32x32x16_bf16 v[116:131], v[36:39], v[100:103], v[116:131]
    v_mfma_f32_32x32x16_bf16 v[116:131], v[40:43], v[104:107], v[116:131]
    v_cvt_pk_bf16_f32 v108, v84, v85
    v_cvt_pk_bf16_f32 v109, v86, v87
    v_cvt_pk_bf16_f32 v110, v88, v89
    v_cvt_pk_bf16_f32 v111, v90, v91
    v_cvt_pk_bf16_f32 v112, v92, v93
    v_cvt_pk_bf16_f32 v113, v94, v95
    v_cvt_pk_bf16_f32 v114, v96, v97
    v_cvt_pk_bf16_f32 v115, v98, v99
    v_max3_f32 v2, v68, v69, v70
    v_max3_f32 v2, v2, v71, v72
    v_max3_f32 v2, v2, v73, v74
    v_max3_f32 v2, v2, v75, v76
    v_max3_f32 v2, v2, v77, v78
    v_max3_f32 v2, v2, v79, v80
    v_max3_f32 v2, v2, v81, v82
    v_max_f32 v2, v2, v83
    v_mov_b32 v3, v2
    s_nop 1
    v_permlane32_swap_b32 v2, v3
    v_max_f32 v2, v2, v3
    v_max_f32 v2, v2, v148
    v_sub_f32 v3, v148, v2
    v_mov_b32 v148, v2
    v_exp_f32 v3, v3
    v_sub_f32 v68, v68, v2
    v_sub_f32 v69, v69, v2
    v_sub_f32 v70, v70, v2
    v_sub_f32 v71, v71, v2
    v_sub_f32 v72, v72, v2
    v_sub_f32 v73, v73, v2
    v_sub_f32 v74, v74, v2
    v_sub_f32 v75, v75, v2
    v_sub_f32 v76, v76, v2
    v_sub_f32 v77, v77, v2
    v_sub_f32 v78, v78, v2
    v_sub_f32 v79, v79, v2
    v_sub_f32 v80, v80, v2
    v_sub_f32 v81, v81, v2
    v_sub_f32 v82, v82, v2
    v_sub_f32 v83, v83, v2
    v_mul_f32 v116, v3, v116
    v_mul_f32 v117, v3, v117
    v_mul_f32 v118, v3, v118
    v_mul_f32 v119, v3, v119
    v_mul_f32 v120, v3, v120
    v_mul_f32 v121, v3, v121
    v_mul_f32 v122, v3, v122
    v_mul_f32 v123, v3, v123
    v_mul_f32 v124, v3, v124
    v_mfma_f32_32x32x16_bf16 v[84:99], v[24:27], v[16:19], 0
    v_exp_f32 v68, v68
    v_exp_f32 v69, v69
    v_exp_f32 v70, v70
    v_exp_f32 v71, v71
    v_exp_f32 v72, v72
    v_exp_f32 v73, v73
    v_exp_f32 v74, v74
    v_exp_f32 v75, v75
    v_exp_f32 v76, v76
    v_exp_f32 v77, v77
    v_exp_f32 v78, v78
    v_exp_f32 v79, v79
    v_exp_f32 v80, v80
    v_exp_f32 v81, v81
    v_exp_f32 v82, v82
    v_exp_f32 v83, v83
    v_mfma_f32_32x32x16_bf16 v[132:147], v[36:39], v[108:111], v[132:147]
    v_mfma_f32_32x32x16_bf16 v[132:147], v[40:43], v[112:115], v[132:147]
    v_cvt_pk_bf16_f32 v100, v68, v69
    v_cvt_pk_bf16_f32 v101, v70, v71
    v_cvt_pk_bf16_f32 v102, v72, v73
    v_cvt_pk_bf16_f32 v103, v74, v75
    v_cvt_pk_bf16_f32 v104, v76, v77
    v_cvt_pk_bf16_f32 v105, v78, v79
    v_cvt_pk_bf16_f32 v106, v80, v81
    v_cvt_pk_bf16_f32 v107, v82, v83
    v_max3_f32 v2, v84, v85, v86
    v_max3_f32 v2, v2, v87, v88
    v_max3_f32 v2, v2, v89, v90
    v_max3_f32 v2, v2, v91, v92
    v_max3_f32 v2, v2, v93, v94
    v_max3_f32 v2, v2, v95, v96
    v_max3_f32 v2, v2, v97, v98
    v_max_f32 v2, v2, v99
    v_mov_b32 v3, v2
    s_nop 1
    v_permlane32_swap_b32 v2, v3
    v_max_f32 v2, v2, v3
    v_max_f32 v2, v2, v149
    v_sub_f32 v3, v149, v2
    v_mov_b32 v149, v2
    v_exp_f32 v3, v3
    v_sub_f32 v84, v84, v2
    v_sub_f32 v85, v85, v2
    v_sub_f32 v86, v86, v2
    v_sub_f32 v87, v87, v2
    v_sub_f32 v88, v88, v2
    v_sub_f32 v89, v89, v2
    v_sub_f32 v90, v90, v2
    v_sub_f32 v91, v91, v2
    v_sub_f32 v92, v92, v2
    v_sub_f32 v93, v93, v2
    v_sub_f32 v94, v94, v2
    v_sub_f32 v95, v95, v2
    v_sub_f32 v96, v96, v2
    v_sub_f32 v97, v97, v2
    v_sub_f32 v98, v98, v2
    v_sub_f32 v99, v99, v2
    v_mul_f32 v132, v3, v132
    v_mul_f32 v133, v3, v133
    v_mul_f32 v134, v3, v134
    v_mul_f32 v135, v3, v135
    v_mul_f32 v136, v3, v136
    v_mul_f32 v137, v3, v137
    v_mul_f32 v138, v3, v138
    v_mul_f32 v139, v3, v139
    v_mul_f32 v140, v3, v140
    s_waitcnt vmcnt(3)
    v_mfma_f32_32x32x16_bf16 v[68:83], v[28:31], v[12:15], 0
    v_exp_f32 v84, v84
    v_exp_f32 v85, v85
    v_exp_f32 v86, v86
    v_exp_f32 v87, v87
    v_exp_f32 v88, v88
    v_exp_f32 v89, v89
    v_exp_f32 v90, v90
    v_exp_f32 v91, v91
    v_exp_f32 v92, v92
    v_exp_f32 v93, v93
    v_exp_f32 v94, v94
    v_exp_f32 v95, v95
    v_exp_f32 v96, v96
    v_exp_f32 v97, v97
    v_exp_f32 v98, v98
    v_exp_f32 v99, v99
    buffer_load_dwordx4 v[20:23], v10, s[16:19], s30 offen sc1
    s_mov_b64 exec, s[32:33]
    buffer_load_dwordx4 v[36:39], v11, s[16:19], s30 offen sc1
    buffer_load_dwordx4 v[40:43], v11, s[16:19], s30 offen offset:512 sc1
    s_mov_b64 exec, -1
    s_add_u32 s30, s30, 2048
    s_and_b32 s30, s30, 0xffff
    v_mfma_f32_32x32x16_bf16 v[116:131], v[44:47], v[100:103], v[116:131]
    v_mfma_f32_32x32x16_bf16 v[116:131], v[48:51], v[104:107], v[116:131]
    v_cvt_pk_bf16_f32 v108, v84, v85
    v_cvt_pk_bf16_f32 v109, v86, v87
    v_cvt_pk_bf16_f32 v110, v88, v89
    v_cvt_pk_bf16_f32 v111, v90, v91
    v_cvt_pk_bf16_f32 v112, v92, v93
    v_cvt_pk_bf16_f32 v113, v94, v95
    v_cvt_pk_bf16_f32 v114, v96, v97
    v_cvt_pk_bf16_f32 v115, v98, v99
    v_max3_f32 v2, v68, v69, v70
    v_max3_f32 v2, v2, v71, v72
    v_max3_f32 v2, v2, v73, v74
    v_max3_f32 v2, v2, v75, v76
    v_max3_f32 v2, v2, v77, v78
    v_max3_f32 v2, v2, v79, v80
    v_max3_f32 v2, v2, v81, v82
    v_max_f32 v2, v2, v83
    v_mov_b32 v3, v2
    s_nop 1
    v_permlane32_swap_b32 v2, v3
    v_max_f32 v2, v2, v3
    v_max_f32 v2, v2, v148
    v_sub_f32 v3, v148, v2
    v_mov_b32 v148, v2
    v_exp_f32 v3, v3
    v_sub_f32 v68, v68, v2
    v_sub_f32 v69, v69, v2
    v_sub_f32 v70, v70, v2
    v_sub_f32 v71, v71, v2
    v_sub_f32 v72, v72, v2
    v_sub_f32 v73, v73, v2
    v_sub_f32 v74, v74, v2
    v_sub_f32 v75, v75, v2
    v_sub_f32 v76, v76, v2
    v_sub_f32 v77, v77, v2
    v_sub_f32 v78, v78, v2
    v_sub_f32 v79, v79, v2
    v_sub_f32 v80, v80, v2
    v_sub_f32 v81, v81, v2
    v_sub_f32 v82, v82, v2
    v_sub_f32 v83, v83, v2
    v_mul_f32 v116, v3, v116
    v_mul_f32 v117, v3, v117
    v_mul_f32 v118, v3, v118
    v_mul_f32 v119, v3, v119
    v_mul_f32 v120, v3, v120
    v_mul_f32 v121, v3, v121
    v_mul_f32 v122, v3, v122
    v_mul_f32 v123, v3, v123
    v_mul_f32 v124, v3, v124
    v_mfma_f32_32x32x16_bf16 v[84:99], v[28:31], v[16:19], 0
    v_exp_f32 v68, v68
    v_exp_f32 v69, v69
    v_exp_f32 v70, v70
    v_exp_f32 v71, v71
    v_exp_f32 v72, v72
    v_exp_f32 v73, v73
    v_exp_f32 v74, v74
    v_exp_f32 v75, v75
    v_exp_f32 v76, v76
    v_exp_f32 v77, v77
    v_exp_f32 v78, v78
    v_exp_f32 v79, v79
    v_exp_f32 v80, v80
    v_exp_f32 v81, v81
    v_exp_f32 v82, v82
    v_exp_f32 v83, v83
    v_mfma_f32_32x32x16_bf16 v[132:147], v[44:47], v[108:111], v[132:147]
    v_mfma_f32_32x32x16_bf16 v[132:147], v[48:51], v[112:115], v[132:147]
    v_cvt_pk_bf16_f32 v100, v68, v69
    v_cvt_pk_bf16_f32 v101, v70, v71
    v_cvt_pk_bf16_f32 v102, v72, v73
    v_cvt_pk_bf16_f32 v103, v74, v75
    v_cvt_pk_bf16_f32 v104, v76, v77
    v_cvt_pk_bf16_f32 v105, v78, v79
    v_cvt_pk_bf16_f32 v106, v80, v81
    v_cvt_pk_bf16_f32 v107, v82, v83
    v_max3_f32 v2, v84, v85, v86
    v_max3_f32 v2, v2, v87, v88
    v_max3_f32 v2, v2, v89, v90
    v_max3_f32 v2, v2, v91, v92
    v_max3_f32 v2, v2, v93, v94
    v_max3_f32 v2, v2, v95, v96
    v_max3_f32 v2, v2, v97, v98
    v_max_f32 v2, v2, v99
    v_mov_b32 v3, v2
    s_nop 1
    v_permlane32_swap_b32 v2, v3
    v_max_f32 v2, v2, v3
    v_max_f32 v2, v2, v149
    v_sub_f32 v3, v149, v2
    v_mov_b32 v149, v2
    v_exp_f32 v3, v3
    v_sub_f32 v84, v84, v2
    v_sub_f32 v85, v85, v2
    v_sub_f32 v86, v86, v2
    v_sub_f32 v87, v87, v2
    v_sub_f32 v88, v88, v2
    v_sub_f32 v89, v89, v2
    v_sub_f32 v90, v90, v2
    v_sub_f32 v91, v91, v2
    v_sub_f32 v92, v92, v2
    v_sub_f32 v93, v93, v2
    v_sub_f32 v94, v94, v2
    v_sub_f32 v95, v95, v2
    v_sub_f32 v96, v96, v2
    v_sub_f32 v97, v97, v2
    v_sub_f32 v98, v98, v2
    v_sub_f32 v99, v99, v2
    v_mul_f32 v132, v3, v132
    v_mul_f32 v133, v3, v133
    v_mul_f32 v134, v3, v134
    v_mul_f32 v135, v3, v135
    v_mul_f32 v136, v3, v136
    v_mul_f32 v137, v3, v137
    v_mul_f32 v138, v3, v138
    v_mul_f32 v139, v3, v139
    v_mul_f32 v140, v3, v140
    s_waitcnt vmcnt(3)
    v_mfma_f32_32x32x16_bf16 v[68:83], v[32:35], v[12:15], 0
    v_exp_f32 v84, v84
    v_exp_f32 v85, v85
    v_exp_f32 v86, v86
    v_exp_f32 v87, v87
    v_exp_f32 v88, v88
    v_exp_f32 v89, v89
    v_exp_f32 v90, v90
    v_exp_f32 v91, v91
    v_exp_f32 v92, v92
    v_exp_f32 v93, v93
    v_exp_f32 v94, v94
    v_exp_f32 v95, v95
    v_exp_f32 v96, v96
    v_exp_f32 v97, v97
    v_exp_f32 v98, v98
    v_exp_f32 v99, v99
    buffer_load_dwordx4 v[24:27], v10, s[16:19], s30 offen sc1
    s_mov_b64 exec, s[32:33]
    buffer_load_dwordx4 v[44:47], v11, s[16:19], s30 offen sc1
    buffer_load_dwordx4 v[48:51], v11, s[16:19], s30 offen offset:512 sc1
    s_mov_b64 exec, -1
    s_add_u32 s30, s30, 2048
    s_and_b32 s30, s30, 0xffff
    v_mfma_f32_32x32x16_bf16 v[116:131], v[52:55], v[100:103], v[116:131]
    v_mfma_f32_32x32x16_bf16 v[116:131], v[56:59], v[104:107], v[116:131]
    v_cvt_pk_bf16_f32 v108, v84, v85
    v_cvt_pk_bf16_f32 v109, v86, v87
    v_cvt_pk_bf16_f32 v110, v88, v89
    v_cvt_pk_bf16_f32 v111, v90, v91
    v_cvt_pk_bf16_f32 v112, v92, v93
    v_cvt_pk_bf16_f32 v113, v94, v95
    v_cvt_pk_bf16_f32 v114, v96, v97
    v_cvt_pk_bf16_f32 v115, v98, v99
    v_max3_f32 v2, v68, v69, v70
    v_max3_f32 v2, v2, v71, v72
    v_max3_f32 v2, v2, v73, v74
    v_max3_f32 v2, v2, v75, v76
    v_max3_f32 v2, v2, v77, v78
    v_max3_f32 v2, v2, v79, v80
    v_max3_f32 v2, v2, v81, v82
    v_max_f32 v2, v2, v83
    v_mov_b32 v3, v2
    s_nop 1
    v_permlane32_swap_b32 v2, v3
    v_max_f32 v2, v2, v3
    v_max_f32 v2, v2, v148
    v_sub_f32 v3, v148, v2
    v_mov_b32 v148, v2
    v_exp_f32 v3, v3
    v_sub_f32 v68, v68, v2
    v_sub_f32 v69, v69, v2
    v_sub_f32 v70, v70, v2
    v_sub_f32 v71, v71, v2
    v_sub_f32 v72, v72, v2
    v_sub_f32 v73, v73, v2
    v_sub_f32 v74, v74, v2
    v_sub_f32 v75, v75, v2
    v_sub_f32 v76, v76, v2
    v_sub_f32 v77, v77, v2
    v_sub_f32 v78, v78, v2
    v_sub_f32 v79, v79, v2
    v_sub_f32 v80, v80, v2
    v_sub_f32 v81, v81, v2
    v_sub_f32 v82, v82, v2
    v_sub_f32 v83, v83, v2
    v_mul_f32 v116, v3, v116
    v_mul_f32 v117, v3, v117
    v_mul_f32 v118, v3, v118
    v_mul_f32 v119, v3, v119
    v_mul_f32 v120, v3, v120
    v_mul_f32 v121, v3, v121
    v_mul_f32 v122, v3, v122
    v_mul_f32 v123, v3, v123
    v_mul_f32 v124, v3, v124
    v_mfma_f32_32x32x16_bf16 v[84:99], v[32:35], v[16:19], 0
    v_exp_f32 v68, v68
    v_exp_f32 v69, v69
    v_exp_f32 v70, v70
    v_exp_f32 v71, v71
    v_exp_f32 v72, v72
    v_exp_f32 v73, v73
    v_exp_f32 v74, v74
    v_exp_f32 v75, v75
    v_exp_f32 v76, v76
    v_exp_f32 v77, v77
    v_exp_f32 v78, v78
    v_exp_f32 v79, v79
    v_exp_f32 v80, v80
    v_exp_f32 v81, v81
    v_exp_f32 v82, v82
    v_exp_f32 v83, v83
    v_mfma_f32_32x32x16_bf16 v[132:147], v[52:55], v[108:111], v[132:147]
    v_mfma_f32_32x32x16_bf16 v[132:147], v[56:59], v[112:115], v[132:147]
    v_cvt_pk_bf16_f32 v100, v68, v69
    v_cvt_pk_bf16_f32 v101, v70, v71
    v_cvt_pk_bf16_f32 v102, v72, v73
    v_cvt_pk_bf16_f32 v103, v74, v75
    v_cvt_pk_bf16_f32 v104, v76, v77
    v_cvt_pk_bf16_f32 v105, v78, v79
    v_cvt_pk_bf16_f32 v106, v80, v81
    v_cvt_pk_bf16_f32 v107, v82, v83
    v_max3_f32 v2, v84, v85, v86
    v_max3_f32 v2, v2, v87, v88
    v_max3_f32 v2, v2, v89, v90
    v_max3_f32 v2, v2, v91, v92
    v_max3_f32 v2, v2, v93, v94
    v_max3_f32 v2, v2, v95, v96
    v_max3_f32 v2, v2, v97, v98
    v_max_f32 v2, v2, v99
    v_mov_b32 v3, v2
    s_nop 1
    v_permlane32_swap_b32 v2, v3
    v_max_f32 v2, v2, v3
    v_max_f32 v2, v2, v149
    v_sub_f32 v3, v149, v2
    v_mov_b32 v149, v2
    v_exp_f32 v3, v3
    v_sub_f32 v84, v84, v2
    v_sub_f32 v85, v85, v2
    v_sub_f32 v86, v86, v2
    v_sub_f32 v87, v87, v2
    v_sub_f32 v88, v88, v2
    v_sub_f32 v89, v89, v2
    v_sub_f32 v90, v90, v2
    v_sub_f32 v91, v91, v2
    v_sub_f32 v92, v92, v2
    v_sub_f32 v93, v93, v2
    v_sub_f32 v94, v94, v2
    v_sub_f32 v95, v95, v2
    v_sub_f32 v96, v96, v2
    v_sub_f32 v97, v97, v2
    v_sub_f32 v98, v98, v2
    v_sub_f32 v99, v99, v2
    v_mul_f32 v132, v3, v132
    v_mul_f32 v133, v3, v133
    v_mul_f32 v134, v3, v134
    v_mul_f32 v135, v3, v135
    v_mul_f32 v136, v3, v136
    v_mul_f32 v137, v3, v137
    v_mul_f32 v138, v3, v138
    v_mul_f32 v139, v3, v139
    v_mul_f32 v140, v3, v140
    s_waitcnt vmcnt(3)
    v_mfma_f32_32x32x16_bf16 v[68:83], v[20:23], v[12:15], 0
    v_exp_f32 v84, v84
    v_exp_f32 v85, v85
    v_exp_f32 v86, v86
    v_exp_f32 v87, v87
    v_exp_f32 v88, v88
    v_exp_f32 v89, v89
    v_exp_f32 v90, v90
    v_exp_f32 v91, v91
    v_exp_f32 v92, v92
    v_exp_f32 v93, v93
    v_exp_f32 v94, v94
    v_exp_f32 v95, v95
    v_exp_f32 v96, v96
    v_exp_f32 v97, v97
    v_exp_f32 v98, v98
    v_exp_f32 v99, v99
    buffer_load_dwordx4 v[28:31], v10, s[16:19], s30 offen sc1
    s_mov_b64 exec, s[32:33]
    buffer_load_dwordx4 v[52:55], v11, s[16:19], s30 offen sc1
    buffer_load_dwordx4 v[56:59], v11, s[16:19], s30 offen offset:512 sc1
    s_mov_b64 exec, -1
    s_add_u32 s30, s30, 2048
    s_and_b32 s30, s30, 0xffff
    v_mfma_f32_32x32x16_bf16 v[116:131], v[60:63], v[100:103], v[116:131]
    v_mfma_f32_32x32x16_bf16 v[116:131], v[64:67], v[104:107], v[116:131]
    v_cvt_pk_bf16_f32 v108, v84, v85
    v_cvt_pk_bf16_f32 v109, v86, v87
    v_cvt_pk_bf16_f32 v110, v88, v89
    v_cvt_pk_bf16_f32 v111, v90, v91
    v_cvt_pk_bf16_f32 v112, v92, v93
    v_cvt_pk_bf16_f32 v113, v94, v95
    v_cvt_pk_bf16_f32 v114, v96, v97
    v_cvt_pk_bf16_f32 v115, v98, v99
    s_sub_u32 s34, s34, 1
    s_cmp_lg_u32 s34, 0
    s_cbranch_scc1 concat_heads__softmax_full_mha__ssm_conv_s4d__prompt_kernel_sloop
    v_mfma_f32_32x32x16_bf16 v[132:147], v[60:63], v[108:111], v[132:147]
    v_mfma_f32_32x32x16_bf16 v[132:147], v[64:67], v[112:115], v[132:147]
    s_waitcnt vmcnt(0)
    s_branch concat_heads__softmax_full_mha__ssm_conv_s4d__prompt_kernel_fin
.p2align 4
concat_heads__softmax_full_mha__ssm_conv_s4d__prompt_kernel_idx:
.short 2048, 1280, 1280, 1280, 1280, 1278, 1278, 1278, 1278, 1278, 1278, 1278
.short 1278, 1278, 1278, 1278, 1276, 1276, 1276, 1276, 1276, 1276, 1276, 1276
.short 1276, 1276, 1276, 1276, 1276, 1274, 1274, 1274, 1274, 1274, 1274, 1274
.short 1274, 1274, 1274, 1274, 1272, 1272, 1272, 1272, 1272, 1272, 1272, 1272
.short 1272, 1272, 1272, 1272, 1272, 1270, 1270, 1270, 1270, 1270, 1270, 1270
.short 1270, 1270, 1270, 1270, 1268, 1268, 1268, 1268, 1268, 1268, 1268, 1268
.short 1268, 1268, 1268, 1268, 1268, 1266, 1266, 1266, 1266, 1266, 1266, 1266
.short 1266, 1266, 1266, 1266, 1264, 1264, 1264, 1264, 1264, 1264, 1264, 1264
.short 1264, 1264, 1264, 1264, 1264, 1262, 1262, 1262, 1262, 1262, 1262, 1262
.short 1262, 1262, 1262, 1262, 1260, 1260, 1260, 1260, 1260, 1260, 1260, 1260
.short 1260, 1260, 1260, 1260, 1260, 1258, 1258, 1258, 1258, 1258, 1258, 1258
.short 1258, 1258, 1258, 1258, 1256, 1256, 1256, 1256, 1256, 1256, 1256, 1256
.short 1256, 1256, 1256, 1256, 1256, 1254, 1254, 1254, 1254, 1254, 1254, 1254
.short 1254, 1254, 1254, 1254, 1252, 1252, 1252, 1252, 1252, 1252, 1252, 1252
.short 1252, 1252, 1252, 1252, 1252, 1250, 1250, 1250, 1250, 1250, 1250, 1250
.short 1250, 1250, 1250, 1250, 1248, 1248, 1248, 1248, 1248, 1248, 1248, 1248
.short 1248, 1248, 1248, 1248, 1248, 1246, 1246, 1246, 1246, 1246, 1246, 1246
.short 1246, 1246, 1246, 1246, 1244, 1244, 1244, 1244, 1244, 1244, 1244, 1244
.short 1244, 1244, 1244, 1244, 1244, 1242, 1242, 1242, 1242, 1242, 1242, 1242
.short 1242, 1242, 1242, 1242, 1240, 1240, 1240, 1240, 1240, 1240, 1240, 1240
.short 1240, 1240, 1240, 1240, 1240, 1238, 1238, 1238, 1238, 1238, 1238, 1238
.short 1238, 1238, 1238, 1238, 1236, 1236, 1236, 1236, 1236, 1236, 1236, 1236
.short 1236, 1236, 1236, 1236, 1236, 1234, 1234, 1234, 1234, 1234, 1234, 1234
.short 1234, 1234, 1234, 1234, 1232, 1232, 1232, 1232, 1232, 1232, 1232, 1232
.short 1232, 1232, 1232, 1232, 1232, 1230, 1230, 1230, 1230, 1230, 1230, 1230
.short 1230, 1230, 1230, 1230, 1228, 1228, 1228, 1228, 1228, 1228, 1228, 1228
.short 1228, 1228, 1228, 1228, 1228, 1226, 1226, 1226, 1226, 1226, 1226, 1226
.short 1226, 1226, 1226, 1226, 1224, 1224, 1224, 1224, 1224, 1224, 1224, 1224
.short 1224, 1224, 1224, 1224, 1224, 1222, 1222, 1222, 1222, 1222, 1222, 1222
.short 1222, 1222, 1222, 1222, 1220, 1220, 1220, 1220, 1220, 1220, 1220, 1220
.short 1220, 1220, 1220, 1220, 1220, 1218, 1218, 1218, 1218, 1218, 1218, 1218
.short 1218, 1218, 1218, 1218, 1216, 1216, 1216, 1216, 1216, 1216, 1216, 1216
.short 1216, 1216, 1216, 1216, 1216, 1214, 1214, 1214, 1214, 1214, 1214, 1214
.short 1214, 1214, 1214, 1214, 1212, 1212, 1212, 1212, 1212, 1212, 1212, 1212
.short 1212, 1212, 1212, 1212, 1212, 1210, 1210, 1210, 1210, 1210, 1210, 1210
.short 1210, 1210, 1210, 1210, 1208, 1208, 1208, 1208, 1208, 1208, 1208, 1208
.short 1208, 1208, 1208, 1208, 1208, 1206, 1206, 1206, 1206, 1206, 1206, 1206
.short 1206, 1206, 1206, 1206, 1204, 1204, 1204, 1204, 1204, 1204, 1204, 1204
.short 1204, 1204, 1204, 1204, 1204, 1202, 1202, 1202, 1202, 1202, 1202, 1202
.short 1202, 1202, 1202, 1202, 1200, 1200, 1200, 1200, 1200, 1200, 1200, 1200
.short 1200, 1200, 1200, 1200, 1200, 1198, 1198, 1198, 1198, 1198, 1198, 1198
.short 1198, 1198, 1198, 1198, 1196, 1196, 1196, 1196, 1196, 1196, 1196, 1196
.short 1196, 1196, 1196, 1196, 1196, 1194, 1194, 1194, 1194, 1194, 1194, 1194
.short 1194, 1194, 1194, 1194, 1192, 1192, 1192, 1192, 1192, 1192, 1192, 1192
.short 1192, 1192, 1192, 1192, 1192, 1190, 1190, 1190, 1190, 1190, 1190, 1190
.short 1190, 1190, 1190, 1190, 1188, 1188, 1188, 1188, 1188, 1188, 1188, 1188
.short 1188, 1188, 1188, 1188, 1188, 1186, 1186, 1186, 1186, 1186, 1186, 1186
.short 1186, 1186, 1186, 1186, 1184, 1184, 1184, 1184, 1184, 1184, 1184, 1184
.short 1184, 1184, 1184, 1184, 1184, 1182, 1182, 1182, 1182, 1182, 1182, 1182
.short 1182, 1182, 1182, 1182, 1180, 1180, 1180, 1180, 1180, 1180, 1180, 1180
.short 1180, 1180, 1180, 1180, 1180, 1178, 1178, 1178, 1178, 1178, 1178, 1178
.short 1178, 1178, 1178, 1178, 1176, 1176, 1176, 1176, 1176, 1176, 1176, 1176
.short 1176, 1176, 1176, 1176, 1176, 1174, 1174, 1174, 1174, 1174, 1174, 1174
.short 1174, 1174, 1174, 1174, 1172, 1172, 1172, 1172, 1172, 1172, 1172, 1172
.short 1172, 1172, 1172, 1172, 1172, 1170, 1170, 1170, 1170, 1170, 1170, 1170
.short 1170, 1170, 1170, 1170, 1168, 1168, 1168, 1168, 1168, 1168, 1168, 1168
.short 1168, 1168, 1168, 1168, 1168, 1166, 1166, 1166, 1166, 1166, 1166, 1166
.short 1166, 1166, 1166, 1166, 1164, 1164, 1164, 1164, 1164, 1164, 1164, 1164
.short 1164, 1164, 1164, 1164, 1164, 1162, 1162, 1162, 1162, 1162, 1162, 1162
.short 1162, 1162, 1162, 1162, 1160, 1160, 1160, 1160, 1160, 1160, 1160, 1160
.short 1160, 1160, 1160, 1160, 1160, 1158, 1158, 1158, 1158, 1158, 1158, 1158
.short 1158, 1158, 1158, 1158, 1156, 1156, 1156, 1156, 1156, 1156, 1156, 1156
.short 1156, 1156, 1156, 1156, 1156, 1154, 1154, 1154, 1154, 1154, 1154, 1154
.short 1154, 1154, 1154, 1154, 1152, 1152, 1152, 1152, 1152, 1152, 1152, 1152
.short 1152, 1152, 1152, 1152, 1152, 1150, 1150, 1150, 1150, 1150, 1150, 1150
.short 1150, 1150, 1150, 1150, 1148, 1148, 1148, 1148, 1148, 1148, 1148, 1148
.short 1148, 1148, 1148, 1148, 1148, 1146, 1146, 1146, 1146, 1146, 1146, 1146
.short 1146, 1146, 1146, 1146, 1144, 1144, 1144, 1144, 1144, 1144, 1144, 1144
.short 1144, 1144, 1144, 1144, 1144, 1142, 1142, 1142, 1142, 1142, 1142, 1142
.short 1142, 1142, 1142, 1142, 1140, 1140, 1140, 1140, 1140, 1140, 1140, 1140
.short 1140, 1140, 1140, 1140, 1140, 1138, 1138, 1138, 1138, 1138, 1138, 1138
.short 1138, 1138, 1138, 1138, 1136, 1136, 1136, 1136, 1136, 1136, 1136, 1136
.short 1136, 1136, 1136, 1136, 1136, 1134, 1134, 1134, 1134, 1134, 1134, 1134
.short 1134, 1134, 1134, 1134, 1132, 1132, 1132, 1132, 1132, 1132, 1132, 1132
.short 1132, 1132, 1132, 1132, 1132, 1130, 1130, 1130, 1130, 1130, 1130, 1130
.short 1130, 1130, 1130, 1130, 1128, 1128, 1128, 1128, 1128, 1128, 1128, 1128
.short 1128, 1128, 1128, 1128, 1128, 1126, 1126, 1126, 1126, 1126, 1126, 1126
.short 1126, 1126, 1126, 1126, 1124, 1124, 1124, 1124, 1124, 1124, 1124, 1124
.short 1124, 1124, 1124, 1124, 1124, 1122, 1122, 1122, 1122, 1122, 1122, 1122
.short 1122, 1122, 1122, 1122, 1120, 1120, 1120, 1120, 1120, 1120, 1120, 1120
.short 1120, 1120, 1120, 1120, 1120, 1118, 1118, 1118, 1118, 1118, 1118, 1118
.short 1118, 1118, 1118, 1118, 1116, 1116, 1116, 1116, 1116, 1116, 1116, 1116
.short 1116, 1116, 1116, 1116, 1116, 1114, 1114, 1114, 1114, 1114, 1114, 1114
.short 1114, 1114, 1114, 1114, 1112, 1112, 1112, 1112, 1112, 1112, 1112, 1112
.short 1112, 1112, 1112, 1112, 1112, 1110, 1110, 1110, 1110, 1110, 1110, 1110
.short 1110, 1110, 1110, 1110, 1108, 1108, 1108, 1108, 1108, 1108, 1108, 1108
.short 1108, 1108, 1108, 1108, 1108, 1106, 1106, 1106, 1106, 1106, 1106, 1106
.short 1106, 1106, 1106, 1106, 1104, 1104, 1104, 1104, 1104, 1104, 1104, 1104
.short 1104, 1104, 1104, 1104, 1104, 1102, 1102, 1102, 1102, 1102, 1102, 1102
.short 1102, 1102, 1102, 1102, 1100, 1100, 1100, 1100, 1100, 1100, 1100, 1100
.short 1100, 1100, 1100, 1100, 1100, 1098, 1098, 1098, 1098, 1098, 1098, 1098
.short 1098, 1098, 1098, 1098, 1096, 1096, 1096, 1096, 1096, 1096, 1096, 1096
.short 1096, 1096, 1096, 1096, 1096, 1094, 1094, 1094, 1094, 1094, 1094, 1094
.short 1094, 1094, 1094, 1094, 1092, 1092, 1092, 1092, 1092, 1092, 1092, 1092
.short 1092, 1092, 1092, 1092, 1092, 1090, 1090, 1090, 1090, 1090, 1090, 1090
.short 1090, 1090, 1090, 1090, 1088, 1088, 1088, 1088, 1088, 1088, 1088, 1088
.short 1088, 1088, 1088, 1088, 1088, 1086, 1086, 1086, 1086, 1086, 1086, 1086
.short 1086, 1086, 1086, 1086, 1084, 1084, 1084, 1084, 1084, 1084, 1084, 1084
.short 1084, 1084, 1084, 1084, 1084, 1082, 1082, 1082, 1082, 1082, 1082, 1082
.short 1082, 1082, 1082, 1082, 1080, 1080, 1080, 1080, 1080, 1080, 1080, 1080
.short 1080, 1080, 1080, 1080, 1080, 1078, 1078, 1078, 1078, 1078, 1078, 1078
.short 1078, 1078, 1078, 1078, 1076, 1076, 1076, 1076, 1076, 1076, 1076, 1076
.short 1076, 1076, 1076, 1076, 1076, 1074, 1074, 1074, 1074, 1074, 1074, 1074
.short 1074, 1074, 1074, 1074, 1072, 1072, 1072, 1072, 1072, 1072, 1072, 1072
.short 1072, 1072, 1072, 1072, 1072, 1070, 1070, 1070, 1070, 1070, 1070, 1070
.short 1070, 1070, 1070, 1070, 1068, 1068, 1068, 1068, 1068, 1068, 1068, 1068
.short 1068, 1068, 1068, 1068, 1068, 1066, 1066, 1066, 1066, 1066, 1066, 1066
.short 1066, 1066, 1066, 1066, 1064, 1064, 1064, 1064, 1064, 1064, 1064, 1064
.short 1064, 1064, 1064, 1064, 1064, 1062, 1062, 1062, 1062, 1062, 1062, 1062
.short 1062, 1062, 1062, 1062, 1060, 1060, 1060, 1060, 1060, 1060, 1060, 1060
.short 1060, 1060, 1060, 1060, 1060, 1058, 1058, 1058, 1058, 1058, 1058, 1058
.short 1058, 1058, 1058, 1058, 1056, 1056, 1056, 1056, 1056, 1056, 1056, 1056
.short 1056, 1056, 1056, 1056, 1056, 1054, 1054, 1054, 1054, 1054, 1054, 1054
.short 1054, 1054, 1054, 1054, 1052, 1052, 1052, 1052, 1052, 1052, 1052, 1052
.short 1052, 1052, 1052, 1052, 1052, 1050, 1050, 1050, 1050, 1050, 1050, 1050
.short 1050, 1050, 1050, 1050, 1048, 1048, 1048, 1048, 1048, 1048, 1048, 1048
.short 1048, 1048, 1048, 1048, 1048, 1046, 1046, 1046, 1046, 1046, 1046, 1046
.short 1046, 1046, 1046, 1046, 1044, 1044, 1044, 1044, 1044, 1044, 1044, 1044
.short 1044, 1044, 1044, 1044, 1044, 1042, 1042, 1042, 1042, 1042, 1042, 1042
.short 1042, 1042, 1042, 1042, 1040, 1040, 1040, 1040, 1040, 1040, 1040, 1040
.short 1040, 1040, 1040, 1040, 1040, 1038, 1038, 1038, 1038, 1038, 1038, 1038
.short 1038, 1038, 1038, 1038, 1036, 1036, 1036, 1036, 1036, 1036, 1036, 1036
.short 1036, 1036, 1036, 1036, 1036, 1034, 1034, 1034, 1034, 1034, 1034, 1034
.short 1034, 1034, 1034, 1034, 1032, 1032, 1032, 1032, 1032, 1032, 1032, 1032
.short 1032, 1032, 1032, 1032, 1032, 1030, 1030, 1030, 1030, 1030, 1030, 1030
.short 1030, 1030, 1030, 1030, 1028, 1028, 1028, 1028, 1028, 1028, 1028, 1028
.short 1028, 1028, 1028, 1028, 1028, 1026, 1026, 1026, 1026, 1026, 1026, 1026
.short 1026, 1026, 1026, 1026, 1024, 1024, 1024, 1024, 1024, 1024, 1024, 1022
.short 1024, 1024, 1024, 1022, 1022, 1022, 958, 958, 958, 958, 958, 1020
.short 958, 958, 958, 1020, 1020, 1020, 956, 956, 956, 956, 956, 1018
.short 956, 956, 956, 1018, 1018, 1018, 954, 954, 954, 954, 954, 1016
.short 954, 954, 954, 1016, 1016, 1016, 952, 952, 952, 952, 952, 1014
.short 952, 952, 952, 1014, 1014, 1014, 950, 950, 950, 950, 950, 1012
.short 950, 950, 950, 1012, 1012, 1012, 948, 948, 948, 948, 948, 1010
.short 948, 948, 948, 1010, 1010, 1010, 946, 946, 946, 946, 946, 1008
.short 946, 946, 946, 1008, 1008, 1008, 944, 944, 944, 944, 944, 1006
.short 944, 944, 944, 1006, 1006, 1006, 942, 942, 942, 942, 942, 1004
.short 942, 942, 942, 1004, 1004, 1004, 940, 940, 940, 940, 940, 1002
.short 940, 940, 940, 1002, 1002, 1002, 938, 938, 938, 938, 938, 1000
.short 938, 938, 938, 1000, 1000, 1000, 936, 936, 936, 936, 936, 998
.short 936, 936, 936, 998, 998, 998, 934, 934, 934, 934, 934, 996
.short 934, 934, 934, 996, 996, 996, 932, 932, 932, 932, 932, 994
.short 932, 932, 932, 994, 994, 994, 930, 930, 930, 930, 930, 992
.short 930, 930, 930, 992, 992, 992, 928, 928, 928, 928, 928, 990
.short 928, 928, 928, 990, 990, 990, 926, 926, 926, 926, 926, 988
.short 926, 926, 926, 988, 988, 988, 924, 924, 924, 924, 924, 986
.short 924, 924, 924, 986, 986, 986, 922, 922, 922, 922, 922, 984
.short 922, 922, 922, 984, 984, 984, 920, 920, 920, 920, 920, 982
.short 920, 920, 920, 982, 982, 982, 918, 918, 918, 918, 918, 980
.short 918, 918, 918, 980, 980, 980, 916, 916, 916, 916, 916, 978
.short 916, 916, 916, 978, 978, 978, 914, 914, 914, 914, 914, 976
.short 914, 914, 914, 976, 976, 976, 912, 912, 912, 912, 912, 974
.short 912, 912, 912, 974, 974, 974, 910, 910, 910, 910, 910, 972
.short 910, 910, 910, 972, 972, 972, 908, 908, 908, 908, 908, 970
.short 908, 908, 908, 970, 970, 970, 906, 906, 906, 906, 906, 968
.short 906, 906, 906, 968, 968, 968, 904, 904, 904, 904, 904, 966
.short 904, 904, 904, 966, 966, 966, 902, 902, 902, 902, 902, 964
.short 902, 902, 902, 964, 964, 964, 900, 900, 900, 900, 900, 962
.short 900, 900, 900, 962, 962, 962, 898, 898, 898, 898, 898, 960
.short 898, 898, 898, 960, 960, 960, 896, 896, 896, 896, 896, 894
.short 896, 896, 896, 894, 894, 894, 830, 830, 830, 830, 830, 892
.short 830, 830, 830, 892, 892, 892, 828, 828, 828, 828, 828, 890
.short 828, 828, 828, 890, 890, 890, 826, 826, 826, 826, 826, 888
.short 826, 826, 826, 888, 888, 888, 824, 824, 824, 824, 824, 886
.short 824, 824, 824, 886, 886, 886, 822, 822, 822, 822, 822, 884
.short 822, 822, 822, 884, 884, 884, 820, 820, 820, 820, 820, 882
.short 820, 820, 820, 882, 882, 882, 818, 818, 818, 818, 818, 880
.short 818, 818, 818, 880, 880, 880, 816, 816, 816, 816, 816, 878
.short 816, 816, 816, 878, 878, 878, 814, 814, 814, 814, 814, 876
.short 814, 814, 814, 876, 876, 876, 812, 812, 812, 812, 812, 874
.short 812, 812, 812, 874, 874, 874, 810, 810, 810, 810, 810, 872
.short 810, 810, 810, 872, 872, 872, 808, 808, 808, 808, 808, 870
.short 808, 808, 808, 870, 870, 870, 806, 806, 806, 806, 806, 868
.short 806, 806, 806, 868, 868, 868, 804, 804, 804, 804, 804, 866
.short 804, 804, 804, 866, 866, 866, 802, 802, 802, 802, 802, 864
.short 802, 802, 802, 864, 864, 864, 800, 800, 800, 800, 800, 862
.short 800, 800, 800, 862, 862, 862, 798, 798, 798, 798, 798, 860
.short 798, 798, 798, 860, 860, 860, 796, 796, 796, 796, 796, 858
.short 796, 796, 796, 858, 858, 858, 794, 794, 794, 794, 794, 856
.short 794, 794, 794, 856, 856, 856, 792, 792, 792, 792, 792, 854
.short 792, 792, 792, 854, 854, 854, 790, 790, 790, 790, 790, 852
.short 790, 790, 790, 852, 852, 852, 788, 788, 788, 788, 788, 850
.short 788, 788, 788, 850, 850, 850, 786, 786, 786, 786, 786, 848
.short 786, 786, 786, 848, 848, 848, 784, 784, 784, 784, 784, 846
.short 784, 784, 784, 846, 846, 846, 782, 782, 782, 782, 782, 844
.short 782, 782, 782, 844, 844, 844, 780, 780, 780, 780, 780, 842
.short 780, 780, 780, 842, 842, 842, 778, 778, 778, 778, 778, 840
.short 778, 778, 778, 840, 840, 840, 776, 776, 776, 776, 776, 838
.short 776, 776, 776, 838, 838, 838, 774, 774, 774, 774, 774, 836
.short 774, 774, 774, 836, 836, 836, 772, 772, 772, 772, 772, 834
.short 772, 772, 772, 834, 834, 834, 770, 770, 770, 770, 770, 832
.short 770, 770, 770, 832, 832, 832, 768, 768, 768, 768, 766, 702
.short 768, 768, 766, 702, 702, 702, 638, 574, 574, 574, 764, 700
.short 574, 574, 764, 700, 700, 700, 636, 572, 572, 572, 762, 698
.short 572, 572, 762, 698, 698, 698, 634, 570, 570, 570, 760, 696
.short 570, 570, 760, 696, 696, 696, 632, 568, 568, 568, 758, 694
.short 568, 568, 758, 694, 694, 694, 630, 566, 566, 566, 756, 692
.short 566, 566, 756, 692, 692, 692, 628, 564, 564, 564, 754, 690
.short 564, 564, 754, 690, 690, 690, 626, 562, 562, 562, 752, 688
.short 562, 562, 752, 688, 688, 688, 624, 560, 560, 560, 750, 686
.short 560, 560, 750, 686, 686, 686, 622, 558, 558, 558, 748, 684
.short 558, 558, 748, 684, 684, 684, 620, 556, 556, 556, 746, 682
.short 556, 556, 746, 682, 682, 682, 618, 554, 554, 554, 744, 680
.short 554, 554, 744, 680, 680, 680, 616, 552, 552, 552, 742, 678
.short 552, 552, 742, 678, 678, 678, 614, 550, 550, 550, 740, 676
.short 550, 550, 740, 676, 676, 676, 612, 548, 548, 548, 738, 674
.short 548, 548, 738, 674, 674, 674, 610, 546, 546, 546, 736, 672
.short 546, 546, 736, 672, 672, 672, 608, 544, 544, 544, 734, 670
.short 544, 544, 734, 670, 670, 670, 606, 542, 542, 542, 732, 668
.short 542, 542, 732, 668, 668, 668, 604, 540, 540, 540, 730, 666
.short 540, 540, 730, 666, 666, 666, 602, 538, 538, 538, 728, 664
.short 538, 538, 728, 664, 664, 664, 600, 536, 536, 536, 726, 662
.short 536, 536, 726, 662, 662, 662, 598, 534, 534, 534, 724, 660
.short 534, 534, 724, 660, 660, 660, 596, 532, 532, 532, 722, 658
.short 532, 532, 722, 658, 658, 658, 594, 530, 530, 530, 720, 656
.short 530, 530, 720, 656, 656, 656, 592, 528, 528, 528, 718, 654
.short 528, 528, 718, 654, 654, 654, 590, 526, 526, 526, 716, 652
.short 526, 526, 716, 652, 652, 652, 588, 524, 524, 524, 714, 650
.short 524, 524, 714, 650, 650, 650, 586, 522, 522, 522, 712, 648
.short 522, 522, 712, 648, 648, 648, 584, 520, 520, 520, 710, 646
.short 520, 520, 710, 646, 646, 646, 582, 518, 518, 518, 708, 644
.short 518, 518, 708, 644, 644, 644, 580, 516, 516, 516, 706, 642
.short 516, 516, 706, 642, 642, 642, 578, 514, 514, 514, 704, 640
.short 514, 514, 704, 640, 640, 640, 576, 512, 512, 510, 446, 382
.short 512, 510, 446, 382, 318, 254, 190, 126, 62, 508, 444, 380
.short 62, 508, 444, 380, 316, 252, 188, 124, 60, 506, 442, 378
.short 60, 506, 442, 378, 314, 250, 186, 122, 58, 504, 440, 376
.short 58, 504, 440, 376, 312, 248, 184, 120, 56, 502, 438, 374
.short 56, 502, 438, 374, 310, 246, 182, 118, 54, 500, 436, 372
.short 54, 500, 436, 372, 308, 244, 180, 116, 52, 498, 434, 370
.short 52, 498, 434, 370, 306, 242, 178, 114, 50, 496, 432, 368
.short 50, 496, 432, 368, 304, 240, 176, 112, 48, 494, 430, 366
.short 48, 494, 430, 366, 302, 238, 174, 110, 46, 492, 428, 364
.short 46, 492, 428, 364, 300, 236, 172, 108, 44, 490, 426, 362
.short 44, 490, 426, 362, 298, 234, 170, 106, 42, 488, 424, 360
.short 42, 488, 424, 360, 296, 232, 168, 104, 40, 486, 422, 358
.short 40, 486, 422, 358, 294, 230, 166, 102, 38, 484, 420, 356
.short 38, 484, 420, 356, 292, 228, 164, 100, 36, 482, 418, 354
.short 36, 482, 418, 354, 290, 226, 162, 98, 34, 480, 416, 352
.short 34, 480, 416, 352, 288, 224, 160, 96, 32, 478, 414, 350
.short 32, 478, 414, 350, 286, 222, 158, 94, 30, 476, 412, 348
.short 30, 476, 412, 348, 284, 220, 156, 92, 28, 474, 410, 346
.short 28, 474, 410, 346, 282, 218, 154, 90, 26, 472, 408, 344
.short 26, 472, 408, 344, 280, 216, 152, 88, 24, 470, 406, 342
.short 24, 470, 406, 342, 278, 214, 150, 86, 22, 468, 404, 340
.short 22, 468, 404, 340, 276, 212, 148, 84, 20, 466, 402, 338
.short 20, 466, 402, 338, 274, 210, 146, 82, 18, 464, 400, 336
.short 18, 464, 400, 336, 272, 208, 144, 80, 16, 462, 398, 334
.short 16, 462, 398, 334, 270, 206, 142, 78, 14, 460, 396, 332
.short 14, 460, 396, 332, 268, 204, 140, 76, 12, 458, 394, 330
.short 12, 458, 394, 330, 266, 202, 138, 74, 10, 456, 392, 328
.short 10, 456, 392, 328, 264, 200, 136, 72, 8, 454, 390, 326
.short 8, 454, 390, 326, 262, 198, 134, 70, 6, 452, 388, 324
.short 6, 452, 388, 324, 260, 196, 132, 68, 4, 450, 386, 322
.short 4, 450, 386, 322, 258, 194, 130, 66, 2, 448, 384, 320
.short 2, 448, 384, 320, 256, 192, 128, 64, 0, 2048, 2048, 2048
concat_heads__softmax_full_mha__ssm_conv_s4d__prompt_kernel_last:
.long 0
.section .rodata,"a"
.p2align 6
.amdhsa_kernel concat_heads__softmax_full_mha__ssm_conv_s4d__prompt_kernel
  .amdhsa_next_free_vgpr 256
  .amdhsa_next_free_sgpr 102
  .amdhsa_accum_offset 256
  .amdhsa_group_segment_fixed_size 0
  .amdhsa_kernarg_size 104
  .amdhsa_user_sgpr_count 2
  .amdhsa_user_sgpr_kernarg_segment_ptr 1
  .amdhsa_system_sgpr_workgroup_id_x 1
  .amdhsa_float_denorm_mode_32 3
.end_amdhsa_kernel
```
